```python
import torch

def _softmax(x, axis=-1):
    return torch.softmax(x, dim=axis)
def _gelu(x):
    return torch.nn.functional.gelu(x, approximate="tanh")
def _silu(x):
    return torch.nn.functional.silu(x)
def _sigmoid(x):
    return torch.sigmoid(x)
def _layernorm(x, axis=-1, eps=1e-5):
    m = x.mean(dim=axis, keepdim=True)
    v = x.var(dim=axis, keepdim=True, unbiased=False)
    return (x - m) / torch.sqrt(v + eps)
def _scatter_add(tgt, idx, src, axis=0):
    return tgt.clone().index_add_(axis, idx, src)
def _segment_sum(src, seg, n):
    out = torch.zeros((n,) + src.shape[1:], dtype=src.dtype)
    return out.index_add_(0, seg, src)
def _pad(x, pw):
    flat = tuple(v for pair in reversed(pw) for v in pair)
    return torch.nn.functional.pad(x, flat)

kernel_name = 'concat_heads__ssm_conv_s4__spectral_gfnet__prompt'

def setup_inputs():

    _w = (lambda a: (lambda t: t.to(torch.bfloat16) if t.is_floating_point() else t)(torch.as_tensor(a)))
    def _A_setup():
        B, L, D, N = 1, 2048, 576, 128
        A_re = -(lambda _x: torch.exp(torch.as_tensor(_x)))((lambda *s: torch.randn(*s, dtype=torch.bfloat16) * 3.2)(D, N))
        A_im = torch.pi * (lambda *s: torch.randn(*s, dtype=torch.bfloat16) * 0.05)(D, N)
        B_re = (lambda *s: torch.randn(*s, dtype=torch.bfloat16) * 0.1)(D, N)
        B_im = (lambda *s: torch.randn(*s, dtype=torch.bfloat16) * 0.1)(D, N)
        C_re = (lambda *s: torch.randn(*s, dtype=torch.bfloat16) * 0.1)(D, N)
        C_im = (lambda *s: torch.randn(*s, dtype=torch.bfloat16) * 0.1)(D, N)
        log_dt = (lambda *s: torch.randn(*s, dtype=torch.bfloat16) * 0.05)(D) * 0.5 - 4.0
        Dskip = (lambda *s: torch.randn(*s, dtype=torch.bfloat16) * 0.05)(D)
        return {
            "u": _w((lambda *s: torch.randn(*s, dtype=torch.bfloat16) * 0.05)(B, L, D)),
            "A_re": _w(A_re),
            "A_im": _w(A_im),
            "B_re": _w(B_re),
            "B_im": _w(B_im),
            "C_re": _w(C_re),
            "C_im": _w(C_im),
            "log_dt": _w(log_dt),
            "Dskip": _w(Dskip),
        }
    _A_in = _A_setup()

    def _B_setup():
        B, S, D = 1, 2048, 576
        Df = D // 2 + 1
        return {
            "x": _w((lambda *s: torch.randn(*s, dtype=torch.bfloat16) * 0.05)(B, S, D)),
            "w_r": _w((lambda *s: torch.randn(*s, dtype=torch.bfloat16) * 1.6)(S, Df) * 0.02),
            "w_i": _w((lambda *s: torch.randn(*s, dtype=torch.bfloat16) * 1.6)(S, Df) * 0.02),
        }
    _B_in = _B_setup()

    return {
        "A_u": _A_in["u"],
        "A_A_re": _A_in["A_re"],
        "A_A_im": _A_in["A_im"],
        "A_B_re": _A_in["B_re"],
        "A_B_im": _A_in["B_im"],
        "A_C_re": _A_in["C_re"],
        "A_C_im": _A_in["C_im"],
        "A_log_dt": _A_in["log_dt"],
        "A_Dskip": _A_in["Dskip"],
        "B_x": _B_in["x"],
        "B_w_r": _B_in["w_r"],
        "B_w_i": _B_in["w_i"],
    }

def reference(A_u, A_A_re, A_A_im, A_B_re, A_B_im, A_C_re, A_C_im, A_log_dt, A_Dskip, B_x, B_w_r, B_w_i):
    def _A_ref(u, A_re, A_im, B_re, B_im, C_re, C_im, log_dt, Dskip):
        Bsz, L, D = u.shape
        dt = torch.exp(log_dt)[:, None]
        A = A_re + 1j * A_im
        Bc = B_re + 1j * B_im
        Cc = C_re + 1j * C_im
        logdA = dt * A
        dB = dt * Bc
        l = (lambda x, dt: x.to(dt))(torch.arange(L), A_re.dtype)
        P = torch.exp(logdA[:, :, None] * l[None, None, :])
        K = torch.einsum("dn,dnl,dn->dl", Cc, P, dB).real
        L2 = 2 * L
        Kp = _pad(K, ((0, 0), (0, L)))
        up = (lambda x, *d: x.permute(*d))(u, 0, 2, 1)
        up = _pad(up, ((0, 0), (0, 0), (0, L)))
        Kf = (lambda x, axes=(-2,-1): torch.fft.rfft2(x.float(), dim=axes))(Kp[:, None, :], axes=(-2, -1))
        Uf = (lambda x, axes=(-2,-1): torch.fft.rfft2(x.float(), dim=axes))(up[:, :, None, :], axes=(-2, -1))
        Yf = Uf * Kf[None, :, :, :]
        y = (lambda x, s, axes=(-2,-1): torch.fft.irfft2(x, s=s, dim=axes).to(torch.bfloat16))(Yf, (1, L2), axes=(-2, -1))[:, :, 0, :L]
        y = (lambda x, *d: x.permute(*d))(y, 0, 2, 1) + u * Dskip[None, None, :]
        return y

    def _B_ref(x, w_r, w_i):
        B, S, D = x.shape
        X = (lambda x, axes=(-2,-1): torch.fft.rfft2(x.float(), dim=axes))(x, axes=(-2, -1))
        W = w_r + 1j * w_i
        X = X * W
        y = (lambda x, s, axes=(-2,-1): torch.fft.irfft2(x, s=s, dim=axes).to(torch.bfloat16))(X, (S, D), axes=(-2, -1))
        return y

    a = _A_ref(A_u, A_A_re, A_A_im, A_B_re, A_B_im, A_C_re, A_C_im, A_log_dt, A_Dskip)
    b = _B_ref(B_x, B_w_r, B_w_i)
    return torch.concatenate([a, b], axis=-1)
```

```asm
; @launch grid=(448,1,1) block=(512,1,1) lds=81920
.amdgcn_target "amdgcn-amd-amdhsa--gfx950"
.text
.globl concat_heads__ssm_conv_s4__spectral_gfnet__prompt_kernel
.p2align 8
.type concat_heads__ssm_conv_s4__spectral_gfnet__prompt_kernel,@function
concat_heads__ssm_conv_s4__spectral_gfnet__prompt_kernel:
    s_load_dwordx16 s[8:23], s[0:1], 0
    s_load_dwordx8 s[24:31], s[0:1], 64
    s_load_dwordx2 s[4:5], s[0:1], 96
    s_load_dwordx2 s[32:33], s[0:1], 112
    s_cmp_ge_u32 s2, 448
    s_cbranch_scc1 EXIT
    v_lshrrev_b32 v2, 6, v0
    v_and_b32 v1, 63, v0
    v_readfirstlane_b32 s40, v2
    s_mov_b32 s73, 0
    s_mov_b32 s41, s2
    s_cmp_lt_u32 s2, 160
    s_cbranch_scc1 RB
    s_sub_u32 s41, s2, 160
RA:
    s_setprio 3
    s_lshr_b32 s57, s41, 5
    s_lshl_b32 s57, s57, 7
    s_add_u32 s57, s57, 128
    s_cmp_ge_u32 s40, 4
    s_cbranch_scc1 UT
    v_mov_b32 v10, 0
    v_mov_b32 v11, 0
    v_mov_b32 v12, 0
    v_mov_b32 v13, 0
    v_mov_b32 v14, 0
    v_mov_b32 v15, 0
    s_lshr_b32 s46, s40, 1
    s_and_b32 s42, s40, 1
    s_lshl_b32 s43, s41, 9
    s_lshl_b32 s44, s40, 7
    s_add_u32 s43, s43, s44
    v_lshl_add_u32 v3, v1, 1, s43
    s_lshl_b32 s45, s41, 2
    s_mul_i32 s47, s40, 8704
    s_add_u32 s47, s47, 41792
    s_waitcnt lgkmcnt(0)
    global_load_short_d16_hi v10, v3, s[10:11]
    global_load_short_d16_hi v11, v3, s[12:13]
    global_load_short_d16_hi v12, v3, s[14:15]
    global_load_short_d16_hi v13, v3, s[16:17]
    global_load_short_d16_hi v14, v3, s[18:19]
    global_load_short_d16_hi v15, v3, s[20:21]
    s_load_dword s48, s[22:23], s45
    s_load_dword s49, s[24:25], s45
    s_load_dword s34, s[32:33], s57
    s_sub_u32 m0, s47, 41792
    v_and_b32 v5, 31, v1
    v_lshrrev_b32 v6, 5, v1
    v_mul_u32_u24 v7, 272, v5
    v_lshl_add_u32 v7, v6, 4, v7
    v_add_u32 v7, s47, v7
    s_mul_i32 s50, s46, 20864
    s_add_u32 s50, s50, 64
    v_lshlrev_b32 v8, 4, v5
    v_lshlrev_b32 v9, 9, v6
    v_add_u32 v8, v8, v9
    v_add_u32 v9, v8, v9
    s_add_u32 s51, s50, 3056
    v_sub_u32 v8, s51, v8
    s_add_u32 s51, s50, 1520
    v_sub_u32 v9, s51, v9
    v_mov_b32 v20, 0
    v_mov_b32 v21, 0
    v_mov_b32 v22, 0
    v_mov_b32 v23, 0
    s_cmp_eq_u32 s42, 0
    s_cselect_b32 s51, 4096, 0
    s_cselect_b32 s52, 0, 10432
    s_add_u32 s51, s51, s52
    s_add_u32 s51, s51, s50
    v_mul_u32_u24 v16, 5216, v6
    v_min_u32 v17, 27, v5
    v_lshl_add_u32 v16, v17, 4, v16
    v_add_u32 v16, s51, v16
    v_mov_b32 v17, s50
    ds_write_b128 v16, v[20:23]
    ds_write_b32 v17, v20 offset:16096
    s_and_b32 s55, s40, 3
    s_lshl_b32 s55, s55, 7
    s_lshr_b32 s56, s40, 2
    s_mul_i32 s56, s56, 20864
    s_sub_u32 s55, s56, s55
    v_and_b32 v93, 1, v1
    v_mul_u32_u24 v94, 5216, v93
    v_lshrrev_b32 v95, 4, v1
    v_lshl_add_u32 v93, v95, 4, v94
    v_lshlrev_b32 v95, 4, v95
    v_sub_u32 v94, v95, v94
    v_bfe_u32 v95, v1, 1, 3
    v_lshl_add_u32 v94, v95, 6, v94
    v_lshlrev_b32 v95, 3, v95
    v_sub_u32 v93, v93, v95
    s_add_u32 s56, s55, 504
    v_add_u32 v93, s56, v93
    s_add_u32 s56, s55, 16096
    v_add_u32 v94, s56, v94
    s_waitcnt lgkmcnt(0)
    s_add_u32 s34, s34, 0x9e3779b9
    s_lshl_b32 s52, s48, 16
    s_and_b32 s48, s48, 0xffff0000
    s_lshl_b32 s53, s49, 16
    s_and_b32 s49, s49, 0xffff0000
    s_cmp_eq_u32 s46, 0
    s_cselect_b32 s48, s52, s48
    s_cselect_b32 s49, s53, s49
    v_mov_b32 v16, 0x3fb8aa3b
    v_mul_f32 v17, s48, v16
    v_exp_f32 v17, v17
    v_cmp_eq_u32 vcc, 0, v1
    v_mov_b32 v18, s49
    v_cvt_pk_bf16_f32 v17, v17, v17
    v_cndmask_b32 v18, 0, v18, vcc
    v_and_b32 v17, 0xffff0000, v17
    v_mul_f32 v16, v17, v16
    v_mul_f32 v19, 0.15915494, v17
    s_waitcnt vmcnt(4)
    v_mul_f32 v20, v16, v10
    v_mul_f32 v21, v19, v11
    v_mul_f32 v28, 0x41000000, v20
    v_mul_f32 v29, 0x41000000, v21
    v_mul_f32 v30, 0x43800000, v20
    v_mul_f32 v31, 0x43800000, v21
    v_fract_f32 v29, v29
    v_fract_f32 v21, v21
    v_fract_f32 v31, v31
    v_exp_f32 v28, v28
    v_cos_f32 v24, v29
    v_sin_f32 v25, v29
    v_exp_f32 v20, v20
    v_cos_f32 v22, v21
    v_sin_f32 v23, v21
    v_exp_f32 v30, v30
    v_cos_f32 v26, v31
    v_sin_f32 v27, v31
    s_waitcnt vmcnt(0)
    v_mul_f32 v32, v14, v12
    v_mul_f32 v33, v14, v13
    v_fma_f32 v32, -v15, v13, v32
    v_fma_f32 v33, v15, v12, v33
    v_mul_f32 v24, v24, v28
    v_mul_f32 v25, v25, v28
    v_mul_f32 v32, v32, v17
    v_mul_f32 v33, -v33, v17
    v_mul_f32 v22, v22, v20
    v_mul_f32 v23, v23, v20
    v_mul_f32 v26, v26, v30
    v_mul_f32 v27, v27, v30
    v_cvt_pk_bf16_f32 v91, v32, v33
    v_pk_mul_f32 v[34:35], v[32:33], v[24:25] op_sel:[0,0] op_sel_hi:[1,0]
    v_pk_fma_f32 v[34:35], v[32:33], v[24:25], v[34:35] op_sel:[1,1,0] op_sel_hi:[0,1,1] neg_hi:[1,0,0]
    ds_write_addtid_b32 v91 offset:41792
    v_mov_b32 v64, 0x3f80
    v_cvt_pk_bf16_f32 v65, v22, v23
    v_cvt_pk_bf16_f32 v92, v34, v35
    v_pk_mul_f32 v[32:33], v[34:35], v[24:25] op_sel:[0,0] op_sel_hi:[1,0]
    v_pk_fma_f32 v[32:33], v[34:35], v[24:25], v[32:33] op_sel:[1,1,0] op_sel_hi:[0,1,1] neg_hi:[1,0,0]
    ds_write_addtid_b32 v92 offset:42064
    v_cvt_pk_bf16_f32 v79, v26, v27
    v_pk_mul_f32 v[36:37], v[22:23], v[22:23] op_sel:[0,0] op_sel_hi:[1,0]
    v_pk_fma_f32 v[36:37], v[22:23], v[22:23], v[36:37] op_sel:[1,1,0] op_sel_hi:[0,1,1] neg_lo:[1,0,0]
    v_cvt_pk_bf16_f32 v91, v32, v33
    v_pk_mul_f32 v[34:35], v[32:33], v[24:25] op_sel:[0,0] op_sel_hi:[1,0]
    v_pk_fma_f32 v[34:35], v[32:33], v[24:25], v[34:35] op_sel:[1,1,0] op_sel_hi:[0,1,1] neg_hi:[1,0,0]
    ds_write_addtid_b32 v91 offset:42336
    v_cvt_pk_bf16_f32 v66, v36, v37
    v_pk_mul_f32 v[38:39], v[26:27], v[26:27] op_sel:[0,0] op_sel_hi:[1,0]
    v_pk_fma_f32 v[38:39], v[26:27], v[26:27], v[38:39] op_sel:[1,1,0] op_sel_hi:[0,1,1] neg_lo:[1,0,0]
    v_cvt_pk_bf16_f32 v92, v34, v35
    v_pk_mul_f32 v[32:33], v[34:35], v[24:25] op_sel:[0,0] op_sel_hi:[1,0]
    v_pk_fma_f32 v[32:33], v[34:35], v[24:25], v[32:33] op_sel:[1,1,0] op_sel_hi:[0,1,1] neg_hi:[1,0,0]
    ds_write_addtid_b32 v92 offset:42608
    v_cvt_pk_bf16_f32 v72, v38, v39
    v_pk_mul_f32 v[40:41], v[36:37], v[22:23] op_sel:[0,0] op_sel_hi:[1,0]
    v_pk_fma_f32 v[40:41], v[36:37], v[22:23], v[40:41] op_sel:[1,1,0] op_sel_hi:[0,1,1] neg_lo:[1,0,0]
    v_cvt_pk_bf16_f32 v91, v32, v33
    v_pk_mul_f32 v[34:35], v[32:33], v[24:25] op_sel:[0,0] op_sel_hi:[1,0]
    v_pk_fma_f32 v[34:35], v[32:33], v[24:25], v[34:35] op_sel:[1,1,0] op_sel_hi:[0,1,1] neg_hi:[1,0,0]
    ds_write_addtid_b32 v91 offset:42880
    v_cvt_pk_bf16_f32 v67, v40, v41
    v_pk_mul_f32 v[42:43], v[36:37], v[36:37] op_sel:[0,0] op_sel_hi:[1,0]
    v_pk_fma_f32 v[42:43], v[36:37], v[36:37], v[42:43] op_sel:[1,1,0] op_sel_hi:[0,1,1] neg_lo:[1,0,0]
    v_cvt_pk_bf16_f32 v92, v34, v35
    v_pk_mul_f32 v[32:33], v[34:35], v[24:25] op_sel:[0,0] op_sel_hi:[1,0]
    v_pk_fma_f32 v[32:33], v[34:35], v[24:25], v[32:33] op_sel:[1,1,0] op_sel_hi:[0,1,1] neg_hi:[1,0,0]
    ds_write_addtid_b32 v92 offset:43152
    v_cvt_pk_bf16_f32 v68, v42, v43
    v_pk_mul_f32 v[44:45], v[38:39], v[26:27] op_sel:[0,0] op_sel_hi:[1,0]
    v_pk_fma_f32 v[44:45], v[38:39], v[26:27], v[44:45] op_sel:[1,1,0] op_sel_hi:[0,1,1] neg_lo:[1,0,0]
    v_cvt_pk_bf16_f32 v91, v32, v33
    v_pk_mul_f32 v[34:35], v[32:33], v[24:25] op_sel:[0,0] op_sel_hi:[1,0]
    v_pk_fma_f32 v[34:35], v[32:33], v[24:25], v[34:35] op_sel:[1,1,0] op_sel_hi:[0,1,1] neg_hi:[1,0,0]
    ds_write_addtid_b32 v91 offset:43424
    v_cvt_pk_bf16_f32 v84, v44, v45
    v_pk_mul_f32 v[46:47], v[38:39], v[38:39] op_sel:[0,0] op_sel_hi:[1,0]
    v_pk_fma_f32 v[46:47], v[38:39], v[38:39], v[46:47] op_sel:[1,1,0] op_sel_hi:[0,1,1] neg_lo:[1,0,0]
    v_cvt_pk_bf16_f32 v92, v34, v35
    v_pk_mul_f32 v[32:33], v[34:35], v[24:25] op_sel:[0,0] op_sel_hi:[1,0]
    v_pk_fma_f32 v[32:33], v[34:35], v[24:25], v[32:33] op_sel:[1,1,0] op_sel_hi:[0,1,1] neg_hi:[1,0,0]
    ds_write_addtid_b32 v92 offset:43696
    v_cvt_pk_bf16_f32 v75, v46, v47
    v_pk_mul_f32 v[48:49], v[42:43], v[22:23] op_sel:[0,0] op_sel_hi:[1,0]
    v_pk_fma_f32 v[48:49], v[42:43], v[22:23], v[48:49] op_sel:[1,1,0] op_sel_hi:[0,1,1] neg_lo:[1,0,0]
    v_cvt_pk_bf16_f32 v91, v32, v33
    v_pk_mul_f32 v[34:35], v[32:33], v[24:25] op_sel:[0,0] op_sel_hi:[1,0]
    v_pk_fma_f32 v[34:35], v[32:33], v[24:25], v[34:35] op_sel:[1,1,0] op_sel_hi:[0,1,1] neg_hi:[1,0,0]
    ds_write_addtid_b32 v91 offset:43968
    v_cvt_pk_bf16_f32 v69, v48, v49
    v_pk_mul_f32 v[50:51], v[42:43], v[36:37] op_sel:[0,0] op_sel_hi:[1,0]
    v_pk_fma_f32 v[50:51], v[42:43], v[36:37], v[50:51] op_sel:[1,1,0] op_sel_hi:[0,1,1] neg_lo:[1,0,0]
    v_cvt_pk_bf16_f32 v92, v34, v35
    v_pk_mul_f32 v[32:33], v[34:35], v[24:25] op_sel:[0,0] op_sel_hi:[1,0]
    v_pk_fma_f32 v[32:33], v[34:35], v[24:25], v[32:33] op_sel:[1,1,0] op_sel_hi:[0,1,1] neg_hi:[1,0,0]
    ds_write_addtid_b32 v92 offset:44240
    v_cvt_pk_bf16_f32 v70, v50, v51
    v_pk_mul_f32 v[52:53], v[42:43], v[40:41] op_sel:[0,0] op_sel_hi:[1,0]
    v_pk_fma_f32 v[52:53], v[42:43], v[40:41], v[52:53] op_sel:[1,1,0] op_sel_hi:[0,1,1] neg_lo:[1,0,0]
    v_cvt_pk_bf16_f32 v91, v32, v33
    v_pk_mul_f32 v[34:35], v[32:33], v[24:25] op_sel:[0,0] op_sel_hi:[1,0]
    v_pk_fma_f32 v[34:35], v[32:33], v[24:25], v[34:35] op_sel:[1,1,0] op_sel_hi:[0,1,1] neg_hi:[1,0,0]
    ds_write_addtid_b32 v91 offset:44512
    v_cvt_pk_bf16_f32 v71, v52, v53
    v_pk_mul_f32 v[54:55], v[46:47], v[26:27] op_sel:[0,0] op_sel_hi:[1,0]
    v_pk_fma_f32 v[54:55], v[46:47], v[26:27], v[54:55] op_sel:[1,1,0] op_sel_hi:[0,1,1] neg_lo:[1,0,0]
    v_cvt_pk_bf16_f32 v92, v34, v35
    v_pk_mul_f32 v[32:33], v[34:35], v[24:25] op_sel:[0,0] op_sel_hi:[1,0]
    v_pk_fma_f32 v[32:33], v[34:35], v[24:25], v[32:33] op_sel:[1,1,0] op_sel_hi:[0,1,1] neg_hi:[1,0,0]
    ds_write_addtid_b32 v92 offset:44784
    v_cvt_pk_bf16_f32 v77, v54, v55
    v_pk_mul_f32 v[56:57], v[46:47], v[38:39] op_sel:[0,0] op_sel_hi:[1,0]
    v_pk_fma_f32 v[56:57], v[46:47], v[38:39], v[56:57] op_sel:[1,1,0] op_sel_hi:[0,1,1] neg_lo:[1,0,0]
    v_cvt_pk_bf16_f32 v91, v32, v33
    v_pk_mul_f32 v[34:35], v[32:33], v[24:25] op_sel:[0,0] op_sel_hi:[1,0]
    v_pk_fma_f32 v[34:35], v[32:33], v[24:25], v[34:35] op_sel:[1,1,0] op_sel_hi:[0,1,1] neg_hi:[1,0,0]
    ds_write_addtid_b32 v91 offset:45056
    v_cvt_pk_bf16_f32 v87, v56, v57
    v_pk_mul_f32 v[58:59], v[46:47], v[44:45] op_sel:[0,0] op_sel_hi:[1,0]
    v_pk_fma_f32 v[58:59], v[46:47], v[44:45], v[58:59] op_sel:[1,1,0] op_sel_hi:[0,1,1] neg_lo:[1,0,0]
    v_cvt_pk_bf16_f32 v92, v34, v35
    v_pk_mul_f32 v[32:33], v[34:35], v[24:25] op_sel:[0,0] op_sel_hi:[1,0]
    v_pk_fma_f32 v[32:33], v[34:35], v[24:25], v[32:33] op_sel:[1,1,0] op_sel_hi:[0,1,1] neg_hi:[1,0,0]
    ds_write_addtid_b32 v92 offset:45328
    v_cvt_pk_bf16_f32 v89, v58, v59
    v_pk_mul_f32 v[60:61], v[26:27], v[36:37] op_sel:[0,0] op_sel_hi:[1,0]
    v_pk_fma_f32 v[60:61], v[26:27], v[36:37], v[60:61] op_sel:[1,1,0] op_sel_hi:[0,1,1] neg_lo:[1,0,0]
    v_cvt_pk_bf16_f32 v91, v32, v33
    v_pk_mul_f32 v[34:35], v[32:33], v[24:25] op_sel:[0,0] op_sel_hi:[1,0]
    v_pk_fma_f32 v[34:35], v[32:33], v[24:25], v[34:35] op_sel:[1,1,0] op_sel_hi:[0,1,1] neg_hi:[1,0,0]
    ds_write_addtid_b32 v91 offset:45600
    v_cvt_pk_bf16_f32 v80, v60, v61
    v_pk_mul_f32 v[62:63], v[26:27], v[42:43] op_sel:[0,0] op_sel_hi:[1,0]
    v_pk_fma_f32 v[62:63], v[26:27], v[42:43], v[62:63] op_sel:[1,1,0] op_sel_hi:[0,1,1] neg_lo:[1,0,0]
    v_cvt_pk_bf16_f32 v92, v34, v35
    v_pk_mul_f32 v[32:33], v[34:35], v[24:25] op_sel:[0,0] op_sel_hi:[1,0]
    v_pk_fma_f32 v[32:33], v[34:35], v[24:25], v[32:33] op_sel:[1,1,0] op_sel_hi:[0,1,1] neg_hi:[1,0,0]
    ds_write_addtid_b32 v92 offset:45872
    v_cvt_pk_bf16_f32 v81, v62, v63
    v_pk_mul_f32 v[60:61], v[26:27], v[50:51] op_sel:[0,0] op_sel_hi:[1,0]
    v_pk_fma_f32 v[60:61], v[26:27], v[50:51], v[60:61] op_sel:[1,1,0] op_sel_hi:[0,1,1] neg_lo:[1,0,0]
    v_cvt_pk_bf16_f32 v91, v32, v33
    v_pk_mul_f32 v[34:35], v[32:33], v[24:25] op_sel:[0,0] op_sel_hi:[1,0]
    v_pk_fma_f32 v[34:35], v[32:33], v[24:25], v[34:35] op_sel:[1,1,0] op_sel_hi:[0,1,1] neg_hi:[1,0,0]
    ds_write_addtid_b32 v91 offset:46144
    v_cvt_pk_bf16_f32 v82, v60, v61
    v_pk_mul_f32 v[62:63], v[26:27], v[24:25] op_sel:[0,0] op_sel_hi:[1,0]
    v_pk_fma_f32 v[62:63], v[26:27], v[24:25], v[62:63] op_sel:[1,1,0] op_sel_hi:[0,1,1] neg_lo:[1,0,0]
    v_cvt_pk_bf16_f32 v92, v34, v35
    v_pk_mul_f32 v[32:33], v[34:35], v[24:25] op_sel:[0,0] op_sel_hi:[1,0]
    v_pk_fma_f32 v[32:33], v[34:35], v[24:25], v[32:33] op_sel:[1,1,0] op_sel_hi:[0,1,1] neg_hi:[1,0,0]
    ds_write_addtid_b32 v92 offset:46416
    v_cvt_pk_bf16_f32 v83, v62, v63
    v_pk_mul_f32 v[60:61], v[38:39], v[42:43] op_sel:[0,0] op_sel_hi:[1,0]
    v_pk_fma_f32 v[60:61], v[38:39], v[42:43], v[60:61] op_sel:[1,1,0] op_sel_hi:[0,1,1] neg_lo:[1,0,0]
    v_cvt_pk_bf16_f32 v91, v32, v33
    v_pk_mul_f32 v[34:35], v[32:33], v[24:25] op_sel:[0,0] op_sel_hi:[1,0]
    v_pk_fma_f32 v[34:35], v[32:33], v[24:25], v[34:35] op_sel:[1,1,0] op_sel_hi:[0,1,1] neg_hi:[1,0,0]
    ds_write_addtid_b32 v91 offset:46688
    v_cvt_pk_bf16_f32 v73, v60, v61
    v_pk_mul_f32 v[62:63], v[38:39], v[24:25] op_sel:[0,0] op_sel_hi:[1,0]
    v_pk_fma_f32 v[62:63], v[38:39], v[24:25], v[62:63] op_sel:[1,1,0] op_sel_hi:[0,1,1] neg_lo:[1,0,0]
    v_cvt_pk_bf16_f32 v92, v34, v35
    v_pk_mul_f32 v[32:33], v[34:35], v[24:25] op_sel:[0,0] op_sel_hi:[1,0]
    v_pk_fma_f32 v[32:33], v[34:35], v[24:25], v[32:33] op_sel:[1,1,0] op_sel_hi:[0,1,1] neg_hi:[1,0,0]
    ds_write_addtid_b32 v92 offset:46960
    v_cvt_pk_bf16_f32 v74, v62, v63
    v_pk_mul_f32 v[60:61], v[44:45], v[42:43] op_sel:[0,0] op_sel_hi:[1,0]
    v_pk_fma_f32 v[60:61], v[44:45], v[42:43], v[60:61] op_sel:[1,1,0] op_sel_hi:[0,1,1] neg_lo:[1,0,0]
    v_cvt_pk_bf16_f32 v91, v32, v33
    v_pk_mul_f32 v[34:35], v[32:33], v[24:25] op_sel:[0,0] op_sel_hi:[1,0]
    v_pk_fma_f32 v[34:35], v[32:33], v[24:25], v[34:35] op_sel:[1,1,0] op_sel_hi:[0,1,1] neg_hi:[1,0,0]
    ds_write_addtid_b32 v91 offset:47232
    v_cvt_pk_bf16_f32 v85, v60, v61
    v_pk_mul_f32 v[62:63], v[44:45], v[24:25] op_sel:[0,0] op_sel_hi:[1,0]
    v_pk_fma_f32 v[62:63], v[44:45], v[24:25], v[62:63] op_sel:[1,1,0] op_sel_hi:[0,1,1] neg_lo:[1,0,0]
    v_cvt_pk_bf16_f32 v92, v34, v35
    v_pk_mul_f32 v[32:33], v[34:35], v[24:25] op_sel:[0,0] op_sel_hi:[1,0]
    v_pk_fma_f32 v[32:33], v[34:35], v[24:25], v[32:33] op_sel:[1,1,0] op_sel_hi:[0,1,1] neg_hi:[1,0,0]
    ds_write_addtid_b32 v92 offset:47504
    v_cvt_pk_bf16_f32 v86, v62, v63
    v_pk_mul_f32 v[60:61], v[46:47], v[24:25] op_sel:[0,0] op_sel_hi:[1,0]
    v_pk_fma_f32 v[60:61], v[46:47], v[24:25], v[60:61] op_sel:[1,1,0] op_sel_hi:[0,1,1] neg_lo:[1,0,0]
    v_cvt_pk_bf16_f32 v91, v32, v33
    v_pk_mul_f32 v[34:35], v[32:33], v[24:25] op_sel:[0,0] op_sel_hi:[1,0]
    v_pk_fma_f32 v[34:35], v[32:33], v[24:25], v[34:35] op_sel:[1,1,0] op_sel_hi:[0,1,1] neg_hi:[1,0,0]
    ds_write_addtid_b32 v91 offset:47776
    v_cvt_pk_bf16_f32 v76, v60, v61
    v_pk_mul_f32 v[62:63], v[54:55], v[24:25] op_sel:[0,0] op_sel_hi:[1,0]
    v_pk_fma_f32 v[62:63], v[54:55], v[24:25], v[62:63] op_sel:[1,1,0] op_sel_hi:[0,1,1] neg_lo:[1,0,0]
    v_cvt_pk_bf16_f32 v92, v34, v35
    v_pk_mul_f32 v[32:33], v[34:35], v[24:25] op_sel:[0,0] op_sel_hi:[1,0]
    v_pk_fma_f32 v[32:33], v[34:35], v[24:25], v[32:33] op_sel:[1,1,0] op_sel_hi:[0,1,1] neg_hi:[1,0,0]
    ds_write_addtid_b32 v92 offset:48048
    v_cvt_pk_bf16_f32 v78, v62, v63
    v_pk_mul_f32 v[60:61], v[56:57], v[24:25] op_sel:[0,0] op_sel_hi:[1,0]
    v_pk_fma_f32 v[60:61], v[56:57], v[24:25], v[60:61] op_sel:[1,1,0] op_sel_hi:[0,1,1] neg_lo:[1,0,0]
    v_cvt_pk_bf16_f32 v91, v32, v33
    v_pk_mul_f32 v[34:35], v[32:33], v[24:25] op_sel:[0,0] op_sel_hi:[1,0]
    v_pk_fma_f32 v[34:35], v[32:33], v[24:25], v[34:35] op_sel:[1,1,0] op_sel_hi:[0,1,1] neg_hi:[1,0,0]
    ds_write_addtid_b32 v91 offset:48320
    v_cvt_pk_bf16_f32 v88, v60, v61
    v_pk_mul_f32 v[62:63], v[58:59], v[24:25] op_sel:[0,0] op_sel_hi:[1,0]
    v_pk_fma_f32 v[62:63], v[58:59], v[24:25], v[62:63] op_sel:[1,1,0] op_sel_hi:[0,1,1] neg_lo:[1,0,0]
    v_cvt_pk_bf16_f32 v92, v34, v35
    v_pk_mul_f32 v[32:33], v[34:35], v[24:25] op_sel:[0,0] op_sel_hi:[1,0]
    v_pk_fma_f32 v[32:33], v[34:35], v[24:25], v[32:33] op_sel:[1,1,0] op_sel_hi:[0,1,1] neg_hi:[1,0,0]
    ds_write_addtid_b32 v92 offset:48592
    v_cvt_pk_bf16_f32 v90, v62, v63
    v_cvt_pk_bf16_f32 v91, v32, v33
    v_pk_mul_f32 v[34:35], v[32:33], v[24:25] op_sel:[0,0] op_sel_hi:[1,0]
    v_pk_fma_f32 v[34:35], v[32:33], v[24:25], v[34:35] op_sel:[1,1,0] op_sel_hi:[0,1,1] neg_hi:[1,0,0]
    ds_write_addtid_b32 v91 offset:48864
    v_cvt_pk_bf16_f32 v92, v34, v35
    v_pk_mul_f32 v[32:33], v[34:35], v[24:25] op_sel:[0,0] op_sel_hi:[1,0]
    v_pk_fma_f32 v[32:33], v[34:35], v[24:25], v[32:33] op_sel:[1,1,0] op_sel_hi:[0,1,1] neg_hi:[1,0,0]
    ds_write_addtid_b32 v92 offset:49136
    v_cvt_pk_bf16_f32 v91, v32, v33
    v_pk_mul_f32 v[34:35], v[32:33], v[24:25] op_sel:[0,0] op_sel_hi:[1,0]
    v_pk_fma_f32 v[34:35], v[32:33], v[24:25], v[34:35] op_sel:[1,1,0] op_sel_hi:[0,1,1] neg_hi:[1,0,0]
    ds_write_addtid_b32 v91 offset:49408
    v_cvt_pk_bf16_f32 v92, v34, v35
    v_pk_mul_f32 v[32:33], v[34:35], v[24:25] op_sel:[0,0] op_sel_hi:[1,0]
    v_pk_fma_f32 v[32:33], v[34:35], v[24:25], v[32:33] op_sel:[1,1,0] op_sel_hi:[0,1,1] neg_hi:[1,0,0]
    ds_write_addtid_b32 v92 offset:49680
    v_cvt_pk_bf16_f32 v91, v32, v33
    v_pk_mul_f32 v[34:35], v[32:33], v[24:25] op_sel:[0,0] op_sel_hi:[1,0]
    v_pk_fma_f32 v[34:35], v[32:33], v[24:25], v[34:35] op_sel:[1,1,0] op_sel_hi:[0,1,1] neg_hi:[1,0,0]
    ds_write_addtid_b32 v91 offset:49952
    v_cvt_pk_bf16_f32 v92, v34, v35
    ds_write_addtid_b32 v92 offset:50224
    ds_read_b128 v[20:23], v7 offset:0
    ds_read_b128 v[24:27], v7 offset:32
    ds_read_b128 v[28:31], v7 offset:64
    ds_read_b128 v[32:35], v7 offset:96
    ds_read_b128 v[36:39], v7 offset:128
    ds_read_b128 v[40:43], v7 offset:160
    ds_read_b128 v[44:47], v7 offset:192
    ds_read_b128 v[48:51], v7 offset:224
    ds_write_addtid_b32 v64 offset:41792
    ds_write_addtid_b32 v65 offset:42064
    ds_write_addtid_b32 v66 offset:42336
    ds_write_addtid_b32 v67 offset:42608
    ds_write_addtid_b32 v68 offset:43968
    ds_write_addtid_b32 v69 offset:44240
    ds_write_addtid_b32 v70 offset:44512
    ds_write_addtid_b32 v71 offset:44784
    ds_write_addtid_b32 v72 offset:46144
    ds_write_addtid_b32 v73 offset:46416
    ds_write_addtid_b32 v74 offset:46688
    ds_write_addtid_b32 v75 offset:46960
    ds_write_addtid_b32 v76 offset:48320
    ds_write_addtid_b32 v77 offset:48592
    ds_write_addtid_b32 v78 offset:48864
    ds_write_addtid_b32 v79 offset:42880
    ds_write_addtid_b32 v79 offset:43152
    ds_write_addtid_b32 v80 offset:43424
    ds_write_addtid_b32 v81 offset:43696
    ds_write_addtid_b32 v81 offset:45056
    ds_write_addtid_b32 v81 offset:45328
    ds_write_addtid_b32 v82 offset:45600
    ds_write_addtid_b32 v83 offset:45872
    ds_write_addtid_b32 v84 offset:47232
    ds_write_addtid_b32 v85 offset:47504
    ds_write_addtid_b32 v86 offset:47776
    ds_write_addtid_b32 v87 offset:48048
    ds_write_addtid_b32 v88 offset:49408
    ds_write_addtid_b32 v89 offset:49680
    ds_write_addtid_b32 v90 offset:49952
    ds_read_b128 v[96:99], v7 offset:0
    ds_read_b128 v[100:103], v7 offset:32
    ds_read_b128 v[104:107], v7 offset:64
    ds_read_b128 v[108:111], v7 offset:96
    ds_read_b128 v[112:115], v7 offset:128
    ds_read_b128 v[116:119], v7 offset:160
    ds_read_b128 v[120:123], v7 offset:192
    ds_read_b128 v[124:127], v7 offset:224
    v_lshl_add_u32 v10, v1, 4, s47
    s_xor_b32 s54, s40, 1
    s_mul_i32 s54, s54, 8704
    s_add_u32 s54, s54, 41792
    v_lshl_add_u32 v11, v1, 4, s54
    s_waitcnt lgkmcnt(7)
    v_mfma_f32_32x32x16_bf16 v[52:67], v[96:99], v[20:23], 0
    s_waitcnt lgkmcnt(6)
    v_mfma_f32_32x32x16_bf16 v[52:67], v[100:103], v[24:27], v[52:67]
    s_waitcnt lgkmcnt(5)
    v_mfma_f32_32x32x16_bf16 v[52:67], v[104:107], v[28:31], v[52:67]
    s_waitcnt lgkmcnt(4)
    v_mfma_f32_32x32x16_bf16 v[52:67], v[108:111], v[32:35], v[52:67]
    s_waitcnt lgkmcnt(3)
    v_mfma_f32_32x32x16_bf16 v[52:67], v[112:115], v[36:39], v[52:67]
    s_waitcnt lgkmcnt(2)
    v_mfma_f32_32x32x16_bf16 v[52:67], v[116:119], v[40:43], v[52:67]
    s_waitcnt lgkmcnt(1)
    v_mfma_f32_32x32x16_bf16 v[52:67], v[120:123], v[44:47], v[52:67]
    s_waitcnt lgkmcnt(0)
    v_mfma_f32_32x32x16_bf16 v[52:67], v[124:127], v[48:51], v[52:67]
    v_and_b32 v12, 3, v0
    v_lshlrev_b32 v12, 3, v12
    v_bfe_u32 v12, s34, v12, 8
    v_lshl_or_b32 v12, v12, 15, v12
    v_and_b32 v124, 0x10001, v12
    v_lshrrev_b32 v125, 2, v12
    v_and_b32 v125, 0x10001, v125
    v_lshrrev_b32 v126, 4, v12
    v_and_b32 v126, 0x10001, v126
    v_lshrrev_b32 v127, 6, v12
    v_and_b32 v127, 0x10001, v127
    s_mov_b32 s35, 0xfffefffe
    s_cmp_eq_u32 s42, 0
    s_cbranch_scc0 KG_odd
    ds_write_b128 v10, v[60:63]
    ds_write_b128 v10, v[64:67] offset:1024
    v_add_f32 v52, v52, v18
    s_lshl_b32 s55, s40, 2
    v_mov_b32 v12, s55
    v_mov_b32 v13, s34
    ds_write_b32 v12, v13 offset:16
    v_xor_b32 v12, 4, v12
    v_mov_b32 v14, 0
    s_mov_b32 s74, 0
    s_branch KG_wef
KG_we:
    s_sleep 2
KG_wef:
    ds_read_b32 v15, v12 offset:16
    ds_read_b128 v[104:107], v14
    s_add_u32 s74, s74, 1
    s_cmp_gt_u32 s74, 48000
    s_cbranch_scc1 KG_wee
    s_waitcnt lgkmcnt(0)
    v_xor_b32 v15, v13, v15
    v_bitop3_b32 v15, v15, v104, v13 bitop3:0xf6
    v_bitop3_b32 v15, v15, v105, v13 bitop3:0xf6
    v_bitop3_b32 v15, v15, v106, v13 bitop3:0xf6
    v_bitop3_b32 v15, v15, v107, v13 bitop3:0xf6
    v_cmp_ne_u32 vcc, 0, v15
    s_cbranch_vccnz KG_we
KG_wee:
    ds_read_b128 v[20:23], v11
    ds_read_b128 v[24:27], v11 offset:1024
    s_waitcnt lgkmcnt(0)
    v_add_f32 v58, v58, v26
    v_add_f32 v59, v59, v27
    v_add_f32 v56, v56, v24
    v_add_f32 v57, v57, v25
    v_add_f32 v54, v54, v22
    v_add_f32 v55, v55, v23
    v_add_f32 v52, v52, v20
    v_add_f32 v53, v53, v21
    v_mov_b32_dpp v13, v59 wave_shr:1 row_mask:0xf bank_mask:0xf bound_ctrl:0
    v_cvt_pk_bf16_f32 v96, v59, v58
    v_cvt_pk_bf16_f32 v97, v57, v56
    v_cvt_pk_bf16_f32 v98, v55, v54
    v_cvt_pk_bf16_f32 v99, v53, v52
    v_cvt_pk_bf16_f32 v100, v58, v57
    v_cvt_pk_bf16_f32 v101, v56, v55
    v_cvt_pk_bf16_f32 v102, v54, v53
    v_cvt_pk_bf16_f32 v103, v52, v13
    ds_write_b128 v8, v[96:99] offset:6240
    ds_write_b128 v8, v[100:103] offset:1024
    s_branch CONV
KG_odd:
    ds_write_b128 v10, v[52:55]
    ds_write_b128 v10, v[56:59] offset:1024
    s_lshl_b32 s55, s40, 2
    v_mov_b32 v12, s55
    v_mov_b32 v13, s34
    ds_write_b32 v12, v13 offset:16
    v_xor_b32 v12, 4, v12
    v_mov_b32 v14, 0
    s_mov_b32 s74, 0
    s_branch KG_wof
KG_wo:
    s_sleep 2
KG_wof:
    ds_read_b32 v15, v12 offset:16
    ds_read_b128 v[104:107], v14
    s_add_u32 s74, s74, 1
    s_cmp_gt_u32 s74, 48000
    s_cbranch_scc1 KG_woe
    s_waitcnt lgkmcnt(0)
    v_xor_b32 v15, v13, v15
    v_bitop3_b32 v15, v15, v104, v13 bitop3:0xf6
    v_bitop3_b32 v15, v15, v105, v13 bitop3:0xf6
    v_bitop3_b32 v15, v15, v106, v13 bitop3:0xf6
    v_bitop3_b32 v15, v15, v107, v13 bitop3:0xf6
    v_cmp_ne_u32 vcc, 0, v15
    s_cbranch_vccnz KG_wo
KG_woe:
    v_and_b32 v12, 1, v1
    v_cmp_eq_u32 vcc, 0, v12
    ds_read_b128 v[20:23], v11
    ds_read_b128 v[24:27], v11 offset:1024
    s_waitcnt lgkmcnt(0)
    v_add_f32 v60, v60, v20
    v_add_f32 v61, v61, v21
    v_add_f32 v62, v62, v22
    v_add_f32 v63, v63, v23
    v_add_f32 v64, v64, v24
    v_add_f32 v65, v65, v25
    v_add_f32 v66, v66, v26
    v_add_f32 v67, v67, v27
    v_cvt_pk_bf16_f32 v96, v62, v62
    v_cvt_pk_bf16_f32 v97, v61, v61
    v_cvt_pk_bf16_f32 v98, v61, v60
    v_cvt_pk_bf16_f32 v99, v60, v60
    v_cvt_pk_bf16_f32 v100, v62, v61
    v_cvt_pk_bf16_f32 v101, v61, v61
    v_cvt_pk_bf16_f32 v102, v60, v60
    v_cvt_pk_bf16_f32 v103, v60, v60
    ds_write_b128 v8, v[96:99] offset:5216
    ds_write_b128 v8, v[100:103] offset:0
    v_cndmask_b32 v13, v64, v63, vcc
    v_cvt_pk_bf16_f32 v104, v64, v64
    v_cvt_pk_bf16_f32 v105, v64, v13
    v_cvt_pk_bf16_f32 v106, v63, v63
    v_cvt_pk_bf16_f32 v107, v63, v63
    v_cvt_pk_bf16_f32 v108, v64, v64
    v_cvt_pk_bf16_f32 v109, v13, v63
    v_cvt_pk_bf16_f32 v110, v63, v63
    v_cvt_pk_bf16_f32 v111, v63, v63
    ds_write_b128 v9, v[104:107] offset:5728
    ds_write_b128 v9, v[108:111] offset:512
    v_cndmask_b32 v13, v66, v65, vcc
    v_cvt_pk_bf16_f32 v112, v66, v66
    v_cvt_pk_bf16_f32 v113, v66, v13
    v_cvt_pk_bf16_f32 v114, v65, v65
    v_cvt_pk_bf16_f32 v115, v65, v65
    v_cvt_pk_bf16_f32 v116, v66, v66
    v_cvt_pk_bf16_f32 v117, v13, v65
    v_cvt_pk_bf16_f32 v118, v65, v65
    v_cvt_pk_bf16_f32 v119, v65, v65
    ds_write_b128 v9, v[112:115] offset:5216
    ds_write_b128 v9, v[116:119] offset:0
    s_branch CONV
UT:
    s_setprio 3
    s_lshr_b32 s42, s41, 5
    s_and_b32 s43, s41, 31
    s_lshl_b32 s43, s43, 2
    s_and_b32 s44, s40, 3
    s_add_u32 s43, s43, s44
    s_mul_i32 s45, s43, 18432
    s_lshl_b32 s46, s42, 7
    s_add_u32 s45, s45, s46
    v_lshrrev_b32 v3, 3, v1
    v_mul_u32_u24 v3, 1152, v3
    v_and_b32 v4, 7, v1
    v_lshl_add_u32 v3, v4, 4, v3
    v_add_u32 v3, s45, v3
    v_add_u32 v4, 9216, v3
    s_lshr_b32 s45, s44, 1
    s_mul_i32 s45, s45, 5216
    s_and_b32 s46, s44, 1
    s_lshl_b32 s46, s46, 11
    s_add_u32 s45, s45, s46
    s_add_u32 s45, s45, 48
    s_mov_b32 m0, s45
    s_waitcnt lgkmcnt(0)
    global_load_lds_dwordx4 v3, s[8:9]
    s_add_u32 m0, m0, 1024
    s_load_dword s34, s[32:33], s57
    global_load_lds_dwordx4 v4, s[8:9]
    v_and_b32 v5, 15, v1
    v_bfe_u32 v6, v1, 4, 1
    v_lshrrev_b32 v10, 5, v1
    v_lshrrev_b32 v7, 2, v5
    v_lshl_add_u32 v8, v6, 3, v7
    v_lshlrev_b32 v8, 7, v8
    v_and_b32 v9, 3, v5
    v_lshl_add_u32 v8, v9, 3, v8
    v_lshl_add_u32 v8, v10, 5, v8
    v_add_u32 v8, s45, v8
    v_and_b32 v9, 1, v1
    v_lshl_add_u32 v9, v9, 1, v6
    s_lshl_b32 s46, s42, 18
    s_lshl_b32 s47, s43, 6
    s_add_u32 s46, s46, s47
    s_add_u32 s46, s46, 5373952
    v_lshrrev_b32 v7, 1, v5
    v_lshl_add_u32 v7, v10, 3, v7
    v_lshlrev_b32 v7, 13, v7
    v_lshl_add_u32 v7, v9, 4, v7
    v_add_u32 v7, s46, v7
    v_add_u32 v11, 131072, v7
    s_waitcnt lgkmcnt(0)
    s_add_u32 s34, s34, 0x9e3779b9
    v_lshlrev_b32 v9, 3, v9
    v_bfe_u32 v9, s34, v9, 8
    v_lshl_or_b32 v9, v9, 15, v9
    v_and_b32 v124, 0x10001, v9
    v_lshrrev_b32 v125, 2, v9
    v_and_b32 v125, 0x10001, v125
    v_lshrrev_b32 v126, 4, v9
    v_and_b32 v126, 0x10001, v126
    v_lshrrev_b32 v127, 6, v9
    v_and_b32 v127, 0x10001, v127
    s_mov_b32 s35, 0xfffefffe
    s_mov_b32 s58, 0x10000
    s_waitcnt vmcnt(0)
    ds_read_b64_tr_b16 v[16:17], v8 offset:0
    ds_read_b64_tr_b16 v[18:19], v8 offset:512
    ds_read_b64_tr_b16 v[20:21], v8 offset:64
    ds_read_b64_tr_b16 v[22:23], v8 offset:576
    s_waitcnt lgkmcnt(2)
    v_pk_add_u16 v16, v16, s58
    v_pk_add_u16 v17, v17, s58
    v_pk_add_u16 v18, v18, s58
    v_pk_add_u16 v19, v19, s58
    v_and_or_b32 v16, v16, s35, v124
    v_and_or_b32 v17, v17, s35, v125
    v_and_or_b32 v18, v18, s35, v126
    v_and_or_b32 v19, v19, s35, v127
    global_store_dwordx4 v7, v[16:19], s[32:33] sc1
    s_waitcnt lgkmcnt(0)
    v_pk_add_u16 v20, v20, s58
    v_pk_add_u16 v21, v21, s58
    v_pk_add_u16 v22, v22, s58
    v_pk_add_u16 v23, v23, s58
    v_and_or_b32 v20, v20, s35, v124
    v_and_or_b32 v21, v21, s35, v125
    v_and_or_b32 v22, v22, s35, v126
    v_and_or_b32 v23, v23, s35, v127
    global_store_dwordx4 v11, v[20:23], s[32:33] sc1
    s_lshl_b32 s44, s44, 2
    v_mov_b32 v9, s44
    v_mov_b32 v10, s34
    ds_write_b32 v9, v10
    v_and_b32 v9, 3, v0
    v_lshlrev_b32 v9, 3, v9
    v_bfe_u32 v9, s34, v9, 8
    v_lshl_or_b32 v9, v9, 15, v9
    v_and_b32 v124, 0x10001, v9
    v_lshrrev_b32 v125, 2, v9
    v_and_b32 v125, 0x10001, v125
    v_lshrrev_b32 v126, 4, v9
    v_and_b32 v126, 0x10001, v126
    v_lshrrev_b32 v127, 6, v9
    v_and_b32 v127, 0x10001, v127
    s_mov_b32 s35, 0xfffefffe
    s_lshl_b32 s42, s41, 13
    s_add_u32 s42, s42, 5369856
    v_lshl_add_u32 v2, v0, 4, s42
    v_add_u32 v3, 4096, v2
    v_bfe_u32 v4, v0, 1, 1
    v_mul_u32_u24 v4, 20864, v4
    v_and_b32 v5, 0xfc, v0
    v_lshl_add_u32 v4, v5, 3, v4
    v_and_b32 v5, 1, v0
    v_lshl_add_u32 v4, v5, 4, v4
    v_add_u32 v4, 10944, v4
    v_add_u32 v5, 5220, v4
    v_add_u32 v6, 7268, v4
    s_and_b32 s55, s40, 3
    s_lshl_b32 s55, s55, 7
    s_lshr_b32 s56, s40, 2
    s_mul_i32 s56, s56, 20864
    s_sub_u32 s55, s56, s55
    v_and_b32 v93, 1, v1
    v_mul_u32_u24 v94, 5216, v93
    v_lshrrev_b32 v95, 4, v1
    v_lshl_add_u32 v93, v95, 4, v94
    v_lshlrev_b32 v95, 4, v95
    v_sub_u32 v94, v95, v94
    v_bfe_u32 v95, v1, 1, 3
    v_lshl_add_u32 v94, v95, 6, v94
    v_lshlrev_b32 v95, 3, v95
    v_sub_u32 v93, v93, v95
    s_add_u32 s56, s55, 504
    v_add_u32 v93, s56, v93
    s_add_u32 s56, s55, 16096
    v_add_u32 v94, s56, v94
    s_sleep 25
UP_px:
    global_load_dwordx4 v[48:51], v2, s[32:33] sc1
    global_load_dwordx4 v[52:55], v3, s[32:33] sc1
    s_waitcnt vmcnt(0)
UP_pc:
    s_mov_b32 s74, 0
UP_pl:
    v_xor_b32 v14, v48, v124
    v_bitop3_b32 v14, v14, v49, v125 bitop3:0xf6
    v_bitop3_b32 v14, v14, v50, v126 bitop3:0xf6
    v_bitop3_b32 v14, v14, v51, v127 bitop3:0xf6
    v_bitop3_b32 v14, v14, v52, v124 bitop3:0xf6
    v_bitop3_b32 v14, v14, v53, v125 bitop3:0xf6
    v_bitop3_b32 v14, v14, v54, v126 bitop3:0xf6
    v_bitop3_b32 v14, v14, v55, v127 bitop3:0xf6
    v_and_b32 v14, 0x10001, v14
    v_cmp_ne_u32 vcc, 0, v14
    s_cbranch_vccz UP_pgo
    v_or_b32_dpp v14, v14, v14 quad_perm:[1,0,3,2] row_mask:0xf bank_mask:0xf
    s_add_u32 s73, s73, 1
    s_nop 0
    v_or_b32_dpp v14, v14, v14 quad_perm:[2,3,0,1] row_mask:0xf bank_mask:0xf
    v_cmp_ne_u32 vcc, 0, v14
    s_cmp_gt_u32 s73, 3000
    s_mov_b64 exec, vcc
    s_cbranch_scc1 UP_pto
    s_sleep 1
    global_load_dwordx4 v[48:51], v2, s[32:33] sc1
    global_load_dwordx4 v[52:55], v3, s[32:33] sc1
    s_mov_b64 exec, -1
    s_waitcnt vmcnt(0)
    s_branch UP_pl
UP_pto:
    s_mov_b64 exec, -1
UP_pgo:
    v_and_b32 v48, s35, v48
    v_and_b32 v49, s35, v49
    v_and_b32 v50, s35, v50
    v_and_b32 v51, s35, v51
    ds_write_b128 v4, v[48:51] offset:0
    ds_write2_b32 v5, v48, v49 offset0:0 offset1:1
    ds_write2_b32 v5, v50, v51 offset0:2 offset1:3
    v_and_b32 v52, s35, v52
    v_and_b32 v53, s35, v53
    v_and_b32 v54, s35, v54
    v_and_b32 v55, s35, v55
    ds_write_b128 v4, v[52:55] offset:2048
    ds_write2_b32 v6, v52, v53 offset0:0 offset1:1
    ds_write2_b32 v6, v54, v55 offset0:2 offset1:3
CONV:
    v_mov_b32 v9, v93
    v_mov_b32 v10, v94
    s_waitcnt vmcnt(0) lgkmcnt(0)
    s_barrier
    s_setprio 0
    ds_read_b64 v[60:61], v9 offset:2112
    ds_read_b64 v[62:63], v9 offset:2120
    ds_read_b128 v[92:95], v10 offset:1600
    ds_read_b64 v[64:65], v9 offset:1600
    ds_read_b64 v[66:67], v9 offset:1608
    ds_read_b128 v[96:99], v10 offset:2112
    ds_read_b64 v[56:57], v9 offset:2624
    ds_read_b64 v[58:59], v9 offset:2632
    ds_read_b128 v[88:91], v10 offset:1088
    ds_read_b64 v[68:69], v9 offset:1088
    ds_read_b64 v[70:71], v9 offset:1096
    ds_read_b128 v[100:103], v10 offset:2624
    ds_read_b64 v[52:53], v9 offset:3136
    ds_read_b64 v[54:55], v9 offset:3144
    ds_read_b128 v[84:87], v10 offset:576
    s_waitcnt lgkmcnt(12)
    v_mfma_f32_16x16x32_bf16 v[40:43], v[60:63], v[92:95], 0
    s_and_b32 s43, s40, 3
    ds_read_b64 v[72:73], v9 offset:576
    ds_read_b64 v[74:75], v9 offset:584
    ds_read_b128 v[104:107], v10 offset:3136
    s_waitcnt lgkmcnt(12)
    v_mfma_f32_16x16x32_bf16 v[44:47], v[64:67], v[92:95], 0
    s_lshl_b32 s51, s43, 13
    s_cmp_lt_u32 s40, 4
    v_mfma_f32_16x16x32_bf16 v[44:47], v[60:63], v[96:99], v[44:47]
    s_cselect_b32 s44, 41152, 0
    s_add_u32 s51, s51, s44
    ds_read_b64 v[76:77], v9 offset:64
    ds_read_b64 v[78:79], v9 offset:72
    ds_read_b128 v[108:111], v10 offset:3648
    s_waitcnt lgkmcnt(12)
    v_mfma_f32_16x16x32_bf16 v[32:35], v[56:59], v[88:91], 0
    v_bfe_u32 v5, v1, 2, 2
    v_lshrrev_b32 v6, 4, v1
    v_mfma_f32_16x16x32_bf16 v[36:39], v[56:59], v[92:95], 0
    v_xor_b32 v13, v5, v6
    v_lshlrev_b32 v13, 4, v13
    v_mfma_f32_16x16x32_bf16 v[36:39], v[60:63], v[88:91], v[36:39]
    v_bfe_u32 v8, v1, 1, 3
    v_lshl_add_u32 v13, v8, 6, v13
    v_mfma_f32_16x16x32_bf16 v[40:43], v[56:59], v[96:99], v[40:43]
    v_and_b32 v7, 1, v1
    v_lshl_add_u32 v13, v7, 3, v13
    v_mfma_f32_16x16x32_bf16 v[40:43], v[64:67], v[88:91], v[40:43]
    v_xor_b32 v12, 128, v13
    v_add_u32 v13, s51, v13
    ds_read_b64 v[48:49], v9 offset:3648
    ds_read_b64 v[50:51], v9 offset:3656
    ds_read_b128 v[80:83], v10 offset:64
    s_waitcnt lgkmcnt(12)
    v_mfma_f32_16x16x32_bf16 v[44:47], v[68:71], v[88:91], v[44:47]
    v_add_u32 v12, s51, v12
    v_lshrrev_b32 v14, 3, v0
    v_mfma_f32_16x16x32_bf16 v[44:47], v[56:59], v[100:103], v[44:47]
    v_lshrrev_b32 v15, 1, v14
    v_lshrrev_b32 v11, 1, v0
    s_waitcnt lgkmcnt(9)
    v_mfma_f32_16x16x32_bf16 v[24:27], v[52:55], v[84:87], 0
    v_xor_b32 v15, v15, v11
    v_mfma_f32_16x16x32_bf16 v[32:35], v[52:55], v[92:95], v[32:35]
    v_and_b32 v15, 3, v15
    v_mfma_f32_16x16x32_bf16 v[32:35], v[60:63], v[84:87], v[32:35]
    v_lshlrev_b32 v15, 4, v15
    v_mfma_f32_16x16x32_bf16 v[36:39], v[52:55], v[96:99], v[36:39]
    v_lshl_add_u32 v14, v14, 6, v15
    v_mfma_f32_16x16x32_bf16 v[36:39], v[64:67], v[84:87], v[36:39]
    v_mul_u32_u24 v15, 4224, v7
    v_mfma_f32_16x16x32_bf16 v[28:31], v[52:55], v[88:91], 0
    v_xor_b32 v14, v14, v15
    v_mfma_f32_16x16x32_bf16 v[28:31], v[56:59], v[84:87], v[28:31]
    v_add_u32 v11, 41152, v14
    v_mfma_f32_16x16x32_bf16 v[40:43], v[52:55], v[100:103], v[40:43]
    s_lshl_b32 s51, s41, 13
    v_mfma_f32_16x16x32_bf16 v[40:43], v[68:71], v[84:87], v[40:43]
    s_add_u32 s51, s51, 5373952
    s_waitcnt lgkmcnt(6)
    v_mfma_f32_16x16x32_bf16 v[44:47], v[72:75], v[84:87], v[44:47]
    v_lshl_add_u32 v15, v0, 4, s51
    v_mfma_f32_16x16x32_bf16 v[44:47], v[52:55], v[104:107], v[44:47]
    s_lshr_b32 s42, s41, 5
    s_waitcnt lgkmcnt(3)
    s_waitcnt lgkmcnt(0)
    v_mfma_f32_16x16x32_bf16 v[28:31], v[60:63], v[80:83], v[28:31]
    s_and_b32 s43, s41, 31
    v_mfma_f32_16x16x32_bf16 v[28:31], v[48:51], v[92:95], v[28:31]
    s_lshl_b32 s46, s42, 18
    ds_read_b64 v[60:61], v9 offset:2048
    ds_read_b64 v[62:63], v9 offset:2056
    ds_read_b128 v[92:95], v10 offset:1536
    v_mfma_f32_16x16x32_bf16 v[32:35], v[64:67], v[80:83], v[32:35]
    s_lshl_b32 s47, s43, 8
    v_mfma_f32_16x16x32_bf16 v[32:35], v[48:51], v[96:99], v[32:35]
    s_add_u32 s46, s46, s47
    ds_read_b64 v[64:65], v9 offset:1536
    ds_read_b64 v[66:67], v9 offset:1544
    ds_read_b128 v[96:99], v10 offset:2048
    v_mfma_f32_16x16x32_bf16 v[24:27], v[56:59], v[80:83], v[24:27]
    s_add_u32 s46, s46, 5373952
    v_mfma_f32_16x16x32_bf16 v[24:27], v[48:51], v[88:91], v[24:27]
    v_lshrrev_b32 v5, 4, v0
    ds_read_b64 v[56:57], v9 offset:2560
    ds_read_b64 v[58:59], v9 offset:2568
    ds_read_b128 v[88:91], v10 offset:1024
    v_mfma_f32_16x16x32_bf16 v[36:39], v[68:71], v[80:83], v[36:39]
    v_and_b32 v6, 15, v0
    v_mfma_f32_16x16x32_bf16 v[36:39], v[48:51], v[100:103], v[36:39]
    v_lshlrev_b32 v2, 13, v5
    ds_read_b64 v[68:69], v9 offset:1024
    ds_read_b64 v[70:71], v9 offset:1032
    ds_read_b128 v[100:103], v10 offset:2560
    v_mfma_f32_16x16x32_bf16 v[20:23], v[52:55], v[80:83], 0
    v_lshl_add_u32 v2, v6, 4, v2
    v_mfma_f32_16x16x32_bf16 v[20:23], v[48:51], v[84:87], v[20:23]
    v_add_u32 v2, s46, v2
    ds_read_b64 v[52:53], v9 offset:3072
    ds_read_b64 v[54:55], v9 offset:3080
    ds_read_b128 v[84:87], v10 offset:512
    v_mfma_f32_16x16x32_bf16 v[40:43], v[72:75], v[80:83], v[40:43]
    v_lshrrev_b32 v3, 6, v0
    v_mfma_f32_16x16x32_bf16 v[40:43], v[48:51], v[104:107], v[40:43]
    v_xor_b32 v3, v3, v6
    ds_read_b64 v[72:73], v9 offset:512
    ds_read_b64 v[74:75], v9 offset:520
    ds_read_b128 v[104:107], v10 offset:3072
    v_mfma_f32_16x16x32_bf16 v[44:47], v[76:79], v[80:83], v[44:47]
    v_lshlrev_b32 v3, 4, v3
    v_mfma_f32_16x16x32_bf16 v[44:47], v[48:51], v[108:111], v[44:47]
    v_lshl_add_u32 v3, v5, 8, v3
    ds_read_b64 v[76:77], v9 offset:0
    ds_read_b64 v[78:79], v9 offset:8
    ds_read_b128 v[108:111], v10 offset:3584
    v_mfma_f32_16x16x32_bf16 v[16:19], v[48:51], v[80:83], 0
    v_and_b32 v6, 7, v0
    ds_read_b64 v[48:49], v9 offset:3584
    ds_read_b64 v[50:51], v9 offset:3592
    ds_read_b128 v[80:83], v10 offset:0
    s_waitcnt lgkmcnt(15)
    v_mfma_f32_16x16x32_bf16 v[40:43], v[60:63], v[92:95], v[40:43]
    v_lshrrev_b32 v4, 5, v0
    s_waitcnt lgkmcnt(15)
    v_mfma_f32_16x16x32_bf16 v[44:47], v[64:67], v[92:95], v[44:47]
    v_xor_b32 v4, v4, v6
    v_mfma_f32_16x16x32_bf16 v[44:47], v[60:63], v[96:99], v[44:47]
    v_lshlrev_b32 v4, 4, v4
    s_waitcnt lgkmcnt(15)
    v_mfma_f32_16x16x32_bf16 v[32:35], v[56:59], v[88:91], v[32:35]
    v_lshl_add_u32 v4, v6, 10, v4
    v_mfma_f32_16x16x32_bf16 v[36:39], v[56:59], v[92:95], v[36:39]
    v_bfe_u32 v7, v0, 3, 2
    v_mfma_f32_16x16x32_bf16 v[36:39], v[60:63], v[88:91], v[36:39]
    v_lshl_add_u32 v4, v7, 2, v4
    v_mfma_f32_16x16x32_bf16 v[40:43], v[56:59], v[96:99], v[40:43]
    v_add_u32 v4, 32768, v4
    v_mfma_f32_16x16x32_bf16 v[40:43], v[64:67], v[88:91], v[40:43]
    s_mul_i32 s46, s43, 147456
    s_waitcnt lgkmcnt(12)
    v_mfma_f32_16x16x32_bf16 v[44:47], v[68:71], v[88:91], v[44:47]
    s_lshl_b32 s47, s42, 7
    v_mfma_f32_16x16x32_bf16 v[44:47], v[56:59], v[100:103], v[44:47]
    s_add_u32 s46, s46, s47
    s_waitcnt lgkmcnt(9)
    v_mfma_f32_16x16x32_bf16 v[24:27], v[52:55], v[84:87], v[24:27]
    v_lshrrev_b32 v5, 3, v0
    v_mfma_f32_16x16x32_bf16 v[32:35], v[52:55], v[92:95], v[32:35]
    v_mul_u32_u24 v5, 2304, v5
    v_mfma_f32_16x16x32_bf16 v[32:35], v[60:63], v[84:87], v[32:35]
    v_lshl_add_u32 v5, v6, 4, v5
    v_mfma_f32_16x16x32_bf16 v[36:39], v[52:55], v[96:99], v[36:39]
    v_add_u32 v5, s46, v5
    v_mfma_f32_16x16x32_bf16 v[36:39], v[64:67], v[84:87], v[36:39]
    v_mfma_f32_16x16x32_bf16 v[28:31], v[52:55], v[88:91], v[28:31]
    v_mfma_f32_16x16x32_bf16 v[28:31], v[56:59], v[84:87], v[28:31]
    v_mfma_f32_16x16x32_bf16 v[40:43], v[52:55], v[100:103], v[40:43]
    v_mfma_f32_16x16x32_bf16 v[40:43], v[68:71], v[84:87], v[40:43]
    s_waitcnt lgkmcnt(6)
    v_mfma_f32_16x16x32_bf16 v[44:47], v[72:75], v[84:87], v[44:47]
    v_mfma_f32_16x16x32_bf16 v[44:47], v[52:55], v[104:107], v[44:47]
    s_waitcnt lgkmcnt(3)
    s_waitcnt lgkmcnt(0)
    v_mfma_f32_16x16x32_bf16 v[28:31], v[60:63], v[80:83], v[28:31]
    v_mfma_f32_16x16x32_bf16 v[28:31], v[48:51], v[92:95], v[28:31]
    v_mfma_f32_16x16x32_bf16 v[32:35], v[64:67], v[80:83], v[32:35]
    v_mfma_f32_16x16x32_bf16 v[32:35], v[48:51], v[96:99], v[32:35]
    v_mfma_f32_16x16x32_bf16 v[24:27], v[56:59], v[80:83], v[24:27]
    v_mfma_f32_16x16x32_bf16 v[24:27], v[48:51], v[88:91], v[24:27]
    v_mfma_f32_16x16x32_bf16 v[36:39], v[68:71], v[80:83], v[36:39]
    v_mfma_f32_16x16x32_bf16 v[36:39], v[48:51], v[100:103], v[36:39]
    v_mfma_f32_16x16x32_bf16 v[20:23], v[52:55], v[80:83], v[20:23]
    v_mfma_f32_16x16x32_bf16 v[20:23], v[48:51], v[84:87], v[20:23]
    v_mfma_f32_16x16x32_bf16 v[40:43], v[72:75], v[80:83], v[40:43]
    v_mfma_f32_16x16x32_bf16 v[40:43], v[48:51], v[104:107], v[40:43]
    v_mfma_f32_16x16x32_bf16 v[44:47], v[76:79], v[80:83], v[44:47]
    v_mfma_f32_16x16x32_bf16 v[44:47], v[48:51], v[108:111], v[44:47]
    v_mfma_f32_16x16x32_bf16 v[16:19], v[48:51], v[80:83], v[16:19]
    s_setprio 3
    s_cmp_lt_u32 s40, 4
    s_cbranch_scc1 CV_w
    s_barrier
CV_w:
    ds_write_b64 v13, v[28:29] offset:1536
    ds_write_b64 v12, v[30:31] offset:5632
    ds_write_b64 v13, v[32:33] offset:2048
    ds_write_b64 v12, v[34:35] offset:6144
    ds_write_b64 v13, v[24:25] offset:1024
    ds_write_b64 v12, v[26:27] offset:5120
    ds_write_b64 v13, v[36:37] offset:2560
    ds_write_b64 v12, v[38:39] offset:6656
    ds_write_b64 v13, v[20:21] offset:512
    ds_write_b64 v12, v[22:23] offset:4608
    ds_write_b64 v13, v[40:41] offset:3072
    ds_write_b64 v12, v[42:43] offset:7168
    ds_write_b64 v13, v[44:45] offset:3584
    ds_write_b64 v12, v[46:47] offset:7680
    s_nop 1
    ds_write_b64 v13, v[16:17] offset:0
    ds_write_b64 v12, v[18:19] offset:4096
    s_cmp_lt_u32 s40, 4
    s_cbranch_scc0 CV_x
    s_barrier
CV_x:
    s_waitcnt lgkmcnt(0)
    s_barrier
    ds_read_b128 v[48:51], v11 offset:0
    ds_read_b128 v[52:55], v11 offset:8192
    ds_read_b128 v[56:59], v11 offset:16384
    ds_read_b128 v[60:63], v11 offset:24576
    ds_read_b128 v[64:67], v14 offset:0
    ds_read_b128 v[68:71], v14 offset:8192
    ds_read_b128 v[72:75], v14 offset:16384
    ds_read_b128 v[76:79], v14 offset:24576
    v_xor_b32 v124, 0x10001, v124
    v_xor_b32 v125, 0x10001, v125
    v_xor_b32 v126, 0x10001, v126
    v_xor_b32 v127, 0x10001, v127
    s_waitcnt lgkmcnt(6)
    v_add_f32 v48, v48, v52
    v_add_f32 v49, v49, v53
    v_add_f32 v50, v50, v54
    v_add_f32 v51, v51, v55
    s_waitcnt lgkmcnt(4)
    v_add_f32 v56, v56, v60
    v_add_f32 v57, v57, v61
    v_add_f32 v58, v58, v62
    v_add_f32 v59, v59, v63
    v_add_f32 v48, v48, v56
    v_add_f32 v49, v49, v57
    v_add_f32 v50, v50, v58
    v_add_f32 v51, v51, v59
    v_add_u32 v48, 0x10000, v48
    v_add_u32 v49, 0x10000, v49
    v_add_u32 v50, 0x10000, v50
    v_add_u32 v51, 0x10000, v51
    s_waitcnt lgkmcnt(2)
    v_add_f32 v64, v64, v68
    v_add_f32 v65, v65, v69
    v_add_f32 v66, v66, v70
    v_add_f32 v67, v67, v71
    s_waitcnt lgkmcnt(0)
    v_add_f32 v72, v72, v76
    v_add_f32 v73, v73, v77
    v_add_f32 v74, v74, v78
    v_add_f32 v75, v75, v79
    v_add_f32 v64, v64, v72
    v_add_f32 v65, v65, v73
    v_add_f32 v66, v66, v74
    v_add_f32 v67, v67, v75
    v_add_u32 v64, 0x10000, v64
    v_add_u32 v65, 0x10000, v65
    v_add_u32 v66, 0x10000, v66
    v_add_u32 v67, 0x10000, v67
    s_mov_b32 s58, 0x07060302
    v_perm_b32 v16, v64, v48, s58
    v_perm_b32 v17, v65, v49, s58
    v_perm_b32 v18, v66, v50, s58
    v_perm_b32 v19, v67, v51, s58
    v_and_or_b32 v16, v16, s35, v124
    v_and_or_b32 v17, v17, s35, v125
    v_and_or_b32 v18, v18, s35, v126
    v_and_or_b32 v19, v19, s35, v127
    global_store_dwordx4 v15, v[16:19], s[32:33] sc1
    s_sleep 26
YT_px:
    global_load_dwordx4 v[20:23], v2, s[32:33] sc1
    s_waitcnt vmcnt(0)
YT_pc:
    s_mov_b32 s74, 0
YT_pl:
    v_xor_b32 v14, v20, v124
    v_bitop3_b32 v14, v14, v21, v125 bitop3:0xf6
    v_bitop3_b32 v14, v14, v22, v126 bitop3:0xf6
    v_bitop3_b32 v14, v14, v23, v127 bitop3:0xf6
    v_and_b32 v14, 0x10001, v14
    v_cmp_ne_u32 vcc, 0, v14
    s_cbranch_vccz YT_pgo
    v_or_b32_dpp v14, v14, v14 quad_perm:[1,0,3,2] row_mask:0xf bank_mask:0xf
    s_add_u32 s73, s73, 1
    s_nop 0
    v_or_b32_dpp v14, v14, v14 quad_perm:[2,3,0,1] row_mask:0xf bank_mask:0xf
    v_cmp_ne_u32 vcc, 0, v14
    s_cmp_gt_u32 s73, 3000
    s_mov_b64 exec, vcc
    s_cbranch_scc1 YT_pto
    s_sleep 1
    global_load_dwordx4 v[20:23], v2, s[32:33] sc1
    s_mov_b64 exec, -1
    s_waitcnt vmcnt(0)
    s_branch YT_pl
YT_pto:
    s_mov_b64 exec, -1
YT_pgo:
    v_and_b32 v20, s35, v20
    v_and_b32 v21, s35, v21
    v_and_b32 v22, s35, v22
    v_and_b32 v23, s35, v23
    ds_write_b128 v3, v[20:23] offset:32768
    s_waitcnt lgkmcnt(0)
    s_barrier
    ds_read2st64_b32 v[24:25], v4 offset0:0 offset1:1
    ds_read2st64_b32 v[26:27], v4 offset0:2 offset1:3
    s_waitcnt lgkmcnt(0)
    global_store_dwordx4 v5, v[24:27], s[4:5] sc1
    s_or_b32 s43, s43, s40
    s_cmp_eq_u32 s43, 0
    s_cbranch_scc0 YT_e
    v_mov_b32 v6, s57
    v_mov_b32 v7, s34
    s_mov_b64 exec, 1
    global_store_dword v6, v7, s[32:33] sc1
YT_e:
    s_endpgm
RB:
    s_setprio 3
    s_mov_b32 s75, 0
    v_lshlrev_b32 v2, 4, v1
    s_lshl_b32 s48, s40, 10
    v_add_u32 v5, s48, v2
    s_getpc_b64 s[36:37]
RB_pc:
    s_add_u32 s36, s36, TAB_B1-RB_pc
    s_addc_u32 s37, s37, 0
    s_cmp_lt_u32 s41, 128
    s_cselect_b32 s44, 4, 0
    s_cmp_lt_u32 s40, s44
    s_cbranch_scc0 RB_h
    s_add_u32 m0, s48, 0
    s_lshl_b32 s45, s40, 9
    global_load_lds_dwordx4 v5, s[36:37]
    s_add_u32 m0, m0, 4096
    v_add_u32 v6, 4096, v5
    global_load_lds_dwordx4 v6, s[36:37]
    s_add_u32 m0, m0, 4096
    v_add_u32 v6, 8192, v5
    global_load_lds_dwordx4 v6, s[36:37]
    s_add_u32 m0, m0, 4096
    v_add_u32 v6, 12288, v5
    global_load_lds_dwordx4 v6, s[36:37]
    s_add_u32 m0, m0, 4096
    v_add_u32 v6, 16384, v5
    global_load_lds_dwordx4 v6, s[36:37]
    s_add_u32 s45, s45, s41
    s_mul_i32 s46, s45, 1152
    s_mul_i32 s47, s40, 4608
    s_add_u32 s47, s47, 20480
    v_add_u32 v8, s46, v2
    v_cmp_gt_u32 vcc, 8, v1
    v_add_u32 v9, 147328, v8
    v_add_u32 v13, 1024, v8
    v_cndmask_b32 v9, v9, v13, vcc
    v_cmp_gt_u32 vcc, 16, v1
    v_add_u32 v10, 294656, v8
    v_add_u32 v13, 148352, v8
    v_cndmask_b32 v10, v10, v13, vcc
    v_cmp_gt_u32 vcc, 24, v1
    v_add_u32 v11, 441984, v8
    v_add_u32 v13, 295680, v8
    v_cndmask_b32 v11, v11, v13, vcc
    v_add_u32 v12, 443008, v8
    s_mov_b32 m0, s47
    s_waitcnt lgkmcnt(0)
    global_load_lds_dwordx4 v8, s[26:27]
    s_add_u32 m0, m0, 1024
    s_load_dword s34, s[32:33], s75
    global_load_lds_dwordx4 v9, s[26:27]
    s_add_u32 m0, m0, 1024
    s_nop 0
    global_load_lds_dwordx4 v10, s[26:27]
    s_add_u32 m0, m0, 1024
    s_nop 0
    global_load_lds_dwordx4 v11, s[26:27]
    s_add_u32 m0, m0, 1024
    s_mov_b32 exec_hi, 0
    global_load_lds_dwordx4 v12, s[26:27]
    s_mov_b64 exec, -1
    s_and_b32 s66, s41, 15
    s_lshr_b32 s67, s41, 4
    s_lshl_b32 s67, s67, 1
    s_lshr_b32 s68, s40, 2
    s_add_u32 s67, s67, s68
    s_and_b32 s69, s40, 3
    v_and_b32 v122, 15, v1
    v_lshrrev_b32 v121, 4, v1
    s_lshl_b32 s50, s69, 12
    s_add_u32 s50, s50, 38912
    v_add_u32 v7, s50, v2
    v_add_u32 v116, 45056, v2
    s_add_u32 s56, s32, 4096
    s_addc_u32 s57, s33, 0
    s_mov_b32 s58, 2621440
    s_mov_b32 s59, 0x20000
    s_add_u32 s60, s32, 4096
    s_addc_u32 s61, s33, 0
    s_mov_b32 s62, 2621440
    s_mov_b32 s63, 0x20000
    s_mov_b32 s64, 65536
    s_mov_b32 s65, 131072
    s_mov_b32 s49, 655360
    v_mul_lo_u32 v120, v121, s49
    v_lshl_add_u32 v120, v122, 2, v120
    s_lshl_b32 s49, s41, 7
    s_lshr_b32 s50, s40, 1
    s_lshl_b32 s50, s50, 14
    s_add_u32 s49, s49, s50
    s_and_b32 s50, s40, 1
    s_lshl_b32 s50, s50, 6
    s_add_u32 s49, s49, s50
    v_add_u32 v120, s49, v120
    v_add_u32 v117, 163840, v120
    v_add_u32 v118, 327680, v120
    v_add_u32 v125, 491520, v120
    v_lshrrev_b32 v119, 2, v122
    v_xor_b32 v119, v119, v121
    v_lshlrev_b32 v119, 4, v119
    v_lshl_add_u32 v119, v122, 6, v119
    v_add_u32 v119, s48, v119
    v_lshlrev_b32 v124, 1, v122
    s_mov_b32 s35, 0xfffefffe
    s_waitcnt lgkmcnt(0)
    s_add_u32 s34, s34, 0x9e3779b9
    v_bfe_u32 v124, s34, v124, 2
    v_lshl_or_b32 v124, v124, 15, v124
    v_and_b32 v124, 0x10001, v124
B1_go:
    s_waitcnt vmcnt(5)
    s_barrier
    s_setprio 2
    ds_read_b128 v[68:71], v2 offset:15360
    ds_read_b128 v[72:75], v2 offset:16384
    ds_read_b128 v[76:79], v2 offset:17408
    ds_read_b128 v[8:11], v2 offset:0
    ds_read_b128 v[12:15], v2 offset:1024
    ds_read_b128 v[16:19], v2 offset:2048
    ds_read_b128 v[20:23], v2 offset:3072
    ds_read_b128 v[24:27], v2 offset:4096
    ds_read_b128 v[28:31], v2 offset:5120
    ds_read_b128 v[32:35], v2 offset:6144
    ds_read_b128 v[36:39], v2 offset:7168
    ds_read_b128 v[40:43], v2 offset:8192
    ds_read_b128 v[44:47], v2 offset:9216
    ds_read_b128 v[48:51], v2 offset:10240
    ds_read_b128 v[52:55], v2 offset:11264
    ds_read_b128 v[56:59], v2 offset:12288
    ds_read_b128 v[60:63], v2 offset:13312
    ds_read_b128 v[64:67], v2 offset:14336
    s_lshl_b32 s51, s40, 4
    s_waitcnt lgkmcnt(15)
    v_add_u32 v68, s47, v68
    v_add_u32 v69, s47, v69
    v_add_u32 v70, s47, v70
    v_add_u32 v71, s47, v71
    v_xor_b32 v72, s51, v72
    v_xor_b32 v73, s51, v73
    v_xor_b32 v74, s51, v74
    v_xor_b32 v75, s51, v75
    v_xor_b32 v76, s51, v76
    v_xor_b32 v77, s51, v77
    s_waitcnt lgkmcnt(0)
    s_barrier
    s_waitcnt vmcnt(0)
    ds_read_b64_tr_b16 v[80:81], v68 offset:0
    ds_read_b64_tr_b16 v[82:83], v69 offset:0
    ds_read_b64_tr_b16 v[84:85], v70 offset:0
    ds_read_b64_tr_b16 v[86:87], v71 offset:0
    ds_read_b64_tr_b16 v[88:89], v68 offset:1152
    ds_read_b64_tr_b16 v[90:91], v69 offset:1152
    s_waitcnt lgkmcnt(4)
    v_mfma_f32_16x16x32_bf16 v[92:95], v[80:83], v[8:11], 0
    v_mfma_f32_16x16x32_bf16 v[96:99], v[80:83], v[12:15], 0
    s_waitcnt lgkmcnt(2)
    v_mfma_f32_16x16x32_bf16 v[100:103], v[84:87], v[8:11], 0
    v_mfma_f32_16x16x32_bf16 v[104:107], v[84:87], v[12:15], 0
    s_waitcnt lgkmcnt(0)
    v_mfma_f32_16x16x32_bf16 v[108:111], v[88:91], v[8:11], 0
    v_mfma_f32_16x16x32_bf16 v[112:115], v[88:91], v[12:15], 0
    s_nop 0
    v_mul_f32 v0, v92, v20
    v_mul_f32 v92, v92, v16
    v_mul_f32 v3, v93, v21
    v_mul_f32 v93, v93, v17
    v_mul_f32 v4, v94, v22
    v_mul_f32 v94, v94, v18
    v_mul_f32 v6, v95, v23
    v_mul_f32 v95, v95, v19
    v_fma_f32 v92, -v96, v20, v92
    v_fma_f32 v96, v96, v16, v0
    v_fma_f32 v93, -v97, v21, v93
    v_fma_f32 v97, v97, v17, v3
    v_fma_f32 v94, -v98, v22, v94
    v_fma_f32 v98, v98, v18, v4
    v_fma_f32 v95, -v99, v23, v95
    v_fma_f32 v99, v99, v19, v6
    v_cvt_pk_bf16_f32 v80, v92, v96
    v_cvt_pk_bf16_f32 v81, v93, v97
    v_cvt_pk_bf16_f32 v82, v94, v98
    v_cvt_pk_bf16_f32 v83, v95, v99
    v_mul_f32 v0, v100, v28
    v_mul_f32 v100, v100, v24
    v_mfma_f32_16x16x32_bf16 v[92:95], v[32:35], v[80:83], 0
    v_mul_f32 v3, v101, v29
    v_mul_f32 v101, v101, v25
    v_mul_f32 v4, v102, v30
    v_mul_f32 v102, v102, v26
    v_mul_f32 v6, v103, v31
    v_mul_f32 v103, v103, v27
    v_fma_f32 v100, -v104, v28, v100
    v_fma_f32 v104, v104, v24, v0
    v_fma_f32 v101, -v105, v29, v101
    v_mfma_f32_16x16x32_bf16 v[96:99], v[36:39], v[80:83], 0
    v_fma_f32 v105, v105, v25, v3
    v_fma_f32 v102, -v106, v30, v102
    v_fma_f32 v106, v106, v26, v4
    v_fma_f32 v103, -v107, v31, v103
    v_fma_f32 v107, v107, v27, v6
    v_cvt_pk_bf16_f32 v84, v100, v104
    v_cvt_pk_bf16_f32 v85, v101, v105
    v_cvt_pk_bf16_f32 v86, v102, v106
    v_cvt_pk_bf16_f32 v87, v103, v107
    v_mul_f32 v0, v108, v20
    v_mul_f32 v108, v108, v16
    v_mfma_f32_16x16x32_bf16 v[100:103], v[40:43], v[80:83], 0
    v_mul_f32 v3, v109, v21
    v_mul_f32 v109, v109, v17
    v_mul_f32 v4, v110, v22
    v_mfma_f32_16x16x32_bf16 v[92:95], v[44:47], v[84:87], v[92:95]
    v_mul_f32 v110, v110, v18
    v_mul_f32 v6, v111, v23
    v_mul_f32 v111, v111, v19
    v_fma_f32 v108, -v112, v20, v108
    v_mfma_f32_16x16x32_bf16 v[96:99], v[48:51], v[84:87], v[96:99]
    v_fma_f32 v112, v112, v16, v0
    v_fma_f32 v109, -v113, v21, v109
    v_fma_f32 v113, v113, v17, v3
    v_mfma_f32_16x16x32_bf16 v[100:103], v[52:55], v[84:87], v[100:103]
    v_fma_f32 v110, -v114, v22, v110
    v_fma_f32 v114, v114, v18, v4
    v_fma_f32 v111, -v115, v23, v111
    v_fma_f32 v115, v115, v19, v6
    v_mfma_f32_16x16x32_bf16 v[104:107], v[56:59], v[84:87], 0
    v_cvt_pk_bf16_f32 v88, v108, v112
    v_cvt_pk_bf16_f32 v89, v109, v113
    v_cvt_pk_bf16_f32 v90, v110, v114
    v_cvt_pk_bf16_f32 v91, v111, v115
    v_mfma_f32_16x16x32_bf16 v[108:111], v[60:63], v[84:87], 0
    v_cvt_pk_bf16_f32 v92, v92, v93
    v_mfma_f32_16x16x32_bf16 v[112:115], v[64:67], v[84:87], 0
    v_cvt_pk_bf16_f32 v94, v94, v95
    v_mfma_f32_16x16x32_bf16 v[104:107], v[32:35], v[88:91], v[104:107]
    v_cvt_pk_bf16_f32 v96, v96, v97
    v_mfma_f32_16x16x32_bf16 v[108:111], v[36:39], v[88:91], v[108:111]
    v_cvt_pk_bf16_f32 v98, v98, v99
    v_mfma_f32_16x16x32_bf16 v[112:115], v[40:43], v[88:91], v[112:115]
    v_cvt_pk_bf16_f32 v100, v100, v101
    v_cvt_pk_bf16_f32 v102, v102, v103
    ds_read_b64_tr_b16 v[80:81], v68 offset:2304
    ds_read_b64_tr_b16 v[82:83], v69 offset:2304
    ds_read_b64_tr_b16 v[84:85], v70 offset:2304
    ds_read_b64_tr_b16 v[86:87], v71 offset:2304
    ds_read_b64_tr_b16 v[88:89], v68 offset:3456
    ds_read_b64_tr_b16 v[90:91], v69 offset:3456
    v_cvt_pk_bf16_f32 v93, v104, v105
    v_cvt_pk_bf16_f32 v95, v106, v107
    v_cvt_pk_bf16_f32 v97, v108, v109
    v_cvt_pk_bf16_f32 v99, v110, v111
    v_cvt_pk_bf16_f32 v101, v112, v113
    v_cvt_pk_bf16_f32 v103, v114, v115
    s_mov_b32 exec_lo, 0x1fff1fff
    s_mov_b32 exec_hi, 0x1fff1fff
    ds_write_b64 v72, v[92:93] offset:0
    ds_write_b64 v73, v[94:95] offset:0
    ds_write_b64 v74, v[96:97] offset:0
    ds_write_b64 v75, v[98:99] offset:0
    ds_write_b64 v76, v[100:101] offset:0
    ds_write_b64 v77, v[102:103] offset:0
    s_mov_b64 exec, -1
    v_xor_b32 v72, 8, v72
    v_xor_b32 v73, 8, v73
    v_xor_b32 v74, 8, v74
    v_xor_b32 v75, 8, v75
    v_xor_b32 v76, 8, v76
    v_xor_b32 v77, 8, v77
    s_waitcnt lgkmcnt(10)
    v_mfma_f32_16x16x32_bf16 v[92:95], v[80:83], v[8:11], 0
    v_mfma_f32_16x16x32_bf16 v[96:99], v[80:83], v[12:15], 0
    s_waitcnt lgkmcnt(8)
    v_mfma_f32_16x16x32_bf16 v[100:103], v[84:87], v[8:11], 0
    v_mfma_f32_16x16x32_bf16 v[104:107], v[84:87], v[12:15], 0
    s_waitcnt lgkmcnt(6)
    v_mfma_f32_16x16x32_bf16 v[108:111], v[88:91], v[8:11], 0
    v_mfma_f32_16x16x32_bf16 v[112:115], v[88:91], v[12:15], 0
    s_nop 0
    v_mul_f32 v0, v92, v20
    v_mul_f32 v92, v92, v16
    v_mul_f32 v3, v93, v21
    v_mul_f32 v93, v93, v17
    v_mul_f32 v4, v94, v22
    v_mul_f32 v94, v94, v18
    v_mul_f32 v6, v95, v23
    v_mul_f32 v95, v95, v19
    v_fma_f32 v92, -v96, v20, v92
    v_fma_f32 v96, v96, v16, v0
    v_fma_f32 v93, -v97, v21, v93
    v_fma_f32 v97, v97, v17, v3
    v_fma_f32 v94, -v98, v22, v94
    v_fma_f32 v98, v98, v18, v4
    v_fma_f32 v95, -v99, v23, v95
    v_fma_f32 v99, v99, v19, v6
    v_cvt_pk_bf16_f32 v80, v92, v96
    v_cvt_pk_bf16_f32 v81, v93, v97
    v_cvt_pk_bf16_f32 v82, v94, v98
    v_cvt_pk_bf16_f32 v83, v95, v99
    v_mul_f32 v0, v100, v28
    v_mul_f32 v100, v100, v24
    v_mfma_f32_16x16x32_bf16 v[92:95], v[32:35], v[80:83], 0
    v_mul_f32 v3, v101, v29
    v_mul_f32 v101, v101, v25
    v_mul_f32 v4, v102, v30
    v_mul_f32 v102, v102, v26
    v_mul_f32 v6, v103, v31
    v_mul_f32 v103, v103, v27
    v_fma_f32 v100, -v104, v28, v100
    v_fma_f32 v104, v104, v24, v0
    v_fma_f32 v101, -v105, v29, v101
    v_mfma_f32_16x16x32_bf16 v[96:99], v[36:39], v[80:83], 0
    v_fma_f32 v105, v105, v25, v3
    v_fma_f32 v102, -v106, v30, v102
    v_fma_f32 v106, v106, v26, v4
    v_fma_f32 v103, -v107, v31, v103
    v_fma_f32 v107, v107, v27, v6
    v_cvt_pk_bf16_f32 v84, v100, v104
    v_cvt_pk_bf16_f32 v85, v101, v105
    v_cvt_pk_bf16_f32 v86, v102, v106
    v_cvt_pk_bf16_f32 v87, v103, v107
    v_mul_f32 v0, v108, v20
    v_mul_f32 v108, v108, v16
    v_mfma_f32_16x16x32_bf16 v[100:103], v[40:43], v[80:83], 0
    v_mul_f32 v3, v109, v21
    v_mul_f32 v109, v109, v17
    v_mul_f32 v4, v110, v22
    v_mfma_f32_16x16x32_bf16 v[92:95], v[44:47], v[84:87], v[92:95]
    v_mul_f32 v110, v110, v18
    v_mul_f32 v6, v111, v23
    v_mul_f32 v111, v111, v19
    v_fma_f32 v108, -v112, v20, v108
    v_mfma_f32_16x16x32_bf16 v[96:99], v[48:51], v[84:87], v[96:99]
    v_fma_f32 v112, v112, v16, v0
    v_fma_f32 v109, -v113, v21, v109
    v_fma_f32 v113, v113, v17, v3
    v_mfma_f32_16x16x32_bf16 v[100:103], v[52:55], v[84:87], v[100:103]
    v_fma_f32 v110, -v114, v22, v110
    v_fma_f32 v114, v114, v18, v4
    v_fma_f32 v111, -v115, v23, v111
    v_fma_f32 v115, v115, v19, v6
    v_mfma_f32_16x16x32_bf16 v[104:107], v[56:59], v[84:87], 0
    v_cvt_pk_bf16_f32 v88, v108, v112
    v_cvt_pk_bf16_f32 v89, v109, v113
    v_cvt_pk_bf16_f32 v90, v110, v114
    v_cvt_pk_bf16_f32 v91, v111, v115
    v_mfma_f32_16x16x32_bf16 v[108:111], v[60:63], v[84:87], 0
    v_cvt_pk_bf16_f32 v92, v92, v93
    v_mfma_f32_16x16x32_bf16 v[112:115], v[64:67], v[84:87], 0
    v_cvt_pk_bf16_f32 v94, v94, v95
    v_mfma_f32_16x16x32_bf16 v[104:107], v[32:35], v[88:91], v[104:107]
    v_cvt_pk_bf16_f32 v96, v96, v97
    v_mfma_f32_16x16x32_bf16 v[108:111], v[36:39], v[88:91], v[108:111]
    v_cvt_pk_bf16_f32 v98, v98, v99
    v_mfma_f32_16x16x32_bf16 v[112:115], v[40:43], v[88:91], v[112:115]
    v_cvt_pk_bf16_f32 v100, v100, v101
    v_cvt_pk_bf16_f32 v102, v102, v103
    ds_read_b128 v[8:11], v116 offset:33792
    ds_read_b128 v[12:15], v116 offset:34816
    v_cvt_pk_bf16_f32 v93, v104, v105
    v_cvt_pk_bf16_f32 v95, v106, v107
    v_cvt_pk_bf16_f32 v97, v108, v109
    v_cvt_pk_bf16_f32 v99, v110, v111
    v_cvt_pk_bf16_f32 v101, v112, v113
    v_cvt_pk_bf16_f32 v103, v114, v115
    s_mov_b32 exec_lo, 0x1fff1fff
    s_mov_b32 exec_hi, 0x1fff1fff
    ds_write_b64 v72, v[92:93] offset:0
    ds_write_b64 v73, v[94:95] offset:0
    ds_write_b64 v74, v[96:97] offset:0
    ds_write_b64 v75, v[98:99] offset:0
    ds_write_b64 v76, v[100:101] offset:0
    ds_write_b64 v77, v[102:103] offset:0
    s_mov_b64 exec, -1
B1_rg:
    s_setprio 3
    s_waitcnt lgkmcnt(0)
    s_barrier
    ds_read_b128 v[28:31], v119 offset:0
    ds_read_b128 v[32:35], v119 offset:8192
    ds_read_b128 v[36:39], v119 offset:16384
    ds_read_b128 v[80:83], v116 offset:32768
    ds_read_b128 v[88:91], v7 offset:0
    ds_read_b128 v[96:99], v7 offset:1024
    ds_read_b128 v[104:107], v7 offset:2048
    ds_read_b128 v[64:67], v7 offset:3072
    s_waitcnt lgkmcnt(7)
    v_mfma_f32_16x16x32_bf16 v[40:43], v[8:11], v[28:31], 0
    v_mfma_f32_16x16x32_bf16 v[44:47], v[12:15], v[28:31], 0
    s_waitcnt lgkmcnt(6)
    v_mfma_f32_16x16x32_bf16 v[48:51], v[8:11], v[32:35], 0
    v_mfma_f32_16x16x32_bf16 v[52:55], v[12:15], v[32:35], 0
    s_waitcnt lgkmcnt(5)
    v_mfma_f32_16x16x32_bf16 v[56:59], v[8:11], v[36:39], 0
    v_mfma_f32_16x16x32_bf16 v[60:63], v[12:15], v[36:39], 0
    s_waitcnt vmcnt(0)
    s_nop 0
    v_cvt_pk_bf16_f32 v28, v40, v44
    v_cvt_pk_bf16_f32 v29, v41, v45
    v_cvt_pk_bf16_f32 v30, v42, v46
    v_cvt_pk_bf16_f32 v31, v43, v47
    v_and_or_b32 v28, v28, s35, v124
    buffer_store_dword v28, v120, s[56:59], 0 offen sc1
    v_and_or_b32 v29, v29, s35, v124
    buffer_store_dword v29, v117, s[56:59], 0 offen sc1
    v_and_or_b32 v30, v30, s35, v124
    buffer_store_dword v30, v118, s[56:59], 0 offen sc1
    v_and_or_b32 v31, v31, s35, v124
    buffer_store_dword v31, v125, s[56:59], 0 offen sc1
    v_cvt_pk_bf16_f32 v32, v48, v52
    v_cvt_pk_bf16_f32 v33, v49, v53
    v_cvt_pk_bf16_f32 v34, v50, v54
    v_cvt_pk_bf16_f32 v35, v51, v55
    v_and_or_b32 v32, v32, s35, v124
    buffer_store_dword v32, v120, s[56:59], s64 offen sc1
    v_and_or_b32 v33, v33, s35, v124
    buffer_store_dword v33, v117, s[56:59], s64 offen sc1
    v_and_or_b32 v34, v34, s35, v124
    buffer_store_dword v34, v118, s[56:59], s64 offen sc1
    v_and_or_b32 v35, v35, s35, v124
    buffer_store_dword v35, v125, s[56:59], s64 offen sc1
    s_cmp_lt_u32 s40, 3
    s_cbranch_scc0 B1_done
    v_cvt_pk_bf16_f32 v36, v56, v60
    v_cvt_pk_bf16_f32 v37, v57, v61
    v_cvt_pk_bf16_f32 v38, v58, v62
    v_cvt_pk_bf16_f32 v39, v59, v63
    v_and_or_b32 v36, v36, s35, v124
    buffer_store_dword v36, v120, s[56:59], s65 offen sc1
    v_and_or_b32 v37, v37, s35, v124
    buffer_store_dword v37, v117, s[56:59], s65 offen sc1
    v_and_or_b32 v38, v38, s35, v124
    buffer_store_dword v38, v118, s[56:59], s65 offen sc1
    v_and_or_b32 v39, v39, s35, v124
    buffer_store_dword v39, v125, s[56:59], s65 offen sc1
B1_done:
    s_cmp_lt_u32 s67, 19
    s_cbranch_scc0 FT_idle
    v_mov_b32 v48, 0
    v_mov_b32 v49, 0
    v_mov_b32 v50, 0
    v_mov_b32 v51, 0
    v_mov_b32 v52, 0
    v_mov_b32 v53, 0
    v_mov_b32 v54, 0
    v_mov_b32 v55, 0
    v_mov_b32 v56, 0
    v_mov_b32 v57, 0
    v_mov_b32 v58, 0
    v_mov_b32 v59, 0
    v_mov_b32 v60, 0
    v_mov_b32 v61, 0
    v_mov_b32 v62, 0
    v_mov_b32 v63, 0
    v_lshrrev_b32 v32, 5, v1
    v_bfe_u32 v33, v1, 4, 1
    s_lshl_b32 s70, s69, 7
    s_lshl_b32 s71, s68, 5
    s_add_u32 s70, s70, s71
    s_add_u32 s70, s70, 25600
    v_lshlrev_b32 v34, 12, v33
    v_lshl_add_u32 v34, v32, 9, v34
    v_lshl_add_u32 v35, v122, 1, v34
    v_add_u32 v35, s70, v35
    s_mul_i32 s70, s66, 10
    s_lshr_b32 s71, s41, 4
    s_add_u32 s70, s70, s71
    s_lshl_b32 s70, s70, 14
    s_lshl_b32 s71, s69, 8
    s_add_u32 s70, s70, s71
    s_lshl_b32 s71, s68, 6
    s_add_u32 s70, s70, s71
    v_lshlrev_b32 v75, 12, v121
    v_lshl_add_u32 v75, v122, 2, v75
    v_add_u32 v75, s70, v75
    v_lshl_add_u32 v4, v122, 4, v34
    s_lshl_b32 s70, s68, 13
    s_lshr_b32 s71, s69, 1
    s_lshl_b32 s71, s71, 8
    s_add_u32 s71, s71, s70
    s_and_b32 s72, s69, 1
    s_lshl_b32 s72, s72, 3
    s_add_u32 s71, s71, s72
    v_add_u32 v4, s71, v4
    s_lshl_b32 s71, s69, 11
    s_add_u32 s70, s70, s71
    v_add_u32 v6, s70, v2
    s_mov_b32 s72, 0x8000
    s_waitcnt lgkmcnt(0)
    s_barrier
    ds_read_u16_d16_hi v48, v35 offset:32768
    ds_read_u16_d16_hi v56, v35 offset:40960
    ds_read_u16_d16_hi v49, v35 offset:33792
    ds_read_u16_d16_hi v57, v35 offset:41984
    ds_read_u16_d16_hi v50, v35 offset:34816
    ds_read_u16_d16_hi v58, v35 offset:43008
    ds_read_u16_d16_hi v51, v35 offset:35840
    ds_read_u16_d16_hi v59, v35 offset:44032
    ds_read_u16_d16_hi v52, v35 offset:32832
    ds_read_u16_d16_hi v60, v35 offset:41024
    ds_read_u16_d16_hi v53, v35 offset:33856
    ds_read_u16_d16_hi v61, v35 offset:42048
    ds_read_u16_d16_hi v54, v35 offset:34880
    ds_read_u16_d16_hi v62, v35 offset:43072
    ds_read_u16_d16_hi v55, v35 offset:35904
    ds_read_u16_d16_hi v63, v35 offset:44096
    s_add_u32 m0, s48, 35840
    s_add_u32 s36, s36, 18432
    s_addc_u32 s37, s37, 0
    global_load_lds_dwordx4 v5, s[36:37]
    s_add_u32 m0, m0, 8192
    v_add_u32 v74, 8192, v5
    global_load_lds_dwordx4 v74, s[36:37]
    s_cmp_lt_u32 s40, 6
    s_cbranch_scc0 B3_d
    s_add_u32 m0, m0, 8192
    v_add_u32 v74, 16384, v5
    global_load_lds_dwordx4 v74, s[36:37]
B3_d:
    v_pk_add_u16 v92, v88, s72 op_sel:[1,0] op_sel_hi:[0,1]
    v_pk_add_u16 v93, v89, s72 op_sel:[1,0] op_sel_hi:[0,1]
    v_pk_add_u16 v94, v90, s72 op_sel:[1,0] op_sel_hi:[0,1]
    v_pk_add_u16 v95, v91, s72 op_sel:[1,0] op_sel_hi:[0,1]
    v_pk_add_u16 v100, v96, s72 op_sel:[1,0] op_sel_hi:[0,1]
    v_pk_add_u16 v101, v97, s72 op_sel:[1,0] op_sel_hi:[0,1]
    v_pk_add_u16 v102, v98, s72 op_sel:[1,0] op_sel_hi:[0,1]
    v_pk_add_u16 v103, v99, s72 op_sel:[1,0] op_sel_hi:[0,1]
    v_pk_add_u16 v84, v80, s72 op_sel:[1,0] op_sel_hi:[0,1]
    v_pk_add_u16 v85, v81, s72 op_sel:[1,0] op_sel_hi:[0,1]
    v_pk_add_u16 v86, v82, s72 op_sel:[1,0] op_sel_hi:[0,1]
    v_pk_add_u16 v87, v83, s72 op_sel:[1,0] op_sel_hi:[0,1]
    v_pk_add_u16 v108, v104, s72 op_sel:[1,0] op_sel_hi:[0,1]
    v_pk_add_u16 v109, v105, s72 op_sel:[1,0] op_sel_hi:[0,1]
    v_pk_add_u16 v110, v106, s72 op_sel:[1,0] op_sel_hi:[0,1]
    v_pk_add_u16 v111, v107, s72 op_sel:[1,0] op_sel_hi:[0,1]
    v_pk_add_u16 v68, v64, s72 op_sel:[1,0] op_sel_hi:[0,1]
    v_pk_add_u16 v69, v65, s72 op_sel:[1,0] op_sel_hi:[0,1]
    v_pk_add_u16 v70, v66, s72 op_sel:[1,0] op_sel_hi:[0,1]
    v_pk_add_u16 v71, v67, s72 op_sel:[1,0] op_sel_hi:[0,1]
    s_waitcnt lgkmcnt(0)
    s_sleep 17
FT_px:
    global_load_dword v8, v75, s[56:57] offset:0 sc1
    global_load_dword v9, v75, s[56:57] offset:1024 sc1
    global_load_dword v10, v75, s[56:57] offset:2048 sc1
    global_load_dword v11, v75, s[56:57] offset:3072 sc1
    global_load_dword v12, v75, s[56:57] offset:128 sc1
    global_load_dword v13, v75, s[56:57] offset:1152 sc1
    global_load_dword v14, v75, s[56:57] offset:2176 sc1
    global_load_dword v15, v75, s[56:57] offset:3200 sc1
    s_add_u32 s73, s73, 1
    s_cmp_gt_u32 s73, 3000
    s_waitcnt vmcnt(4)
    v_xor_b32 v8, v8, v124
    v_xor_b32 v9, v9, v124
    v_or_b32 v32, v8, v9
    v_xor_b32 v10, v10, v124
    v_xor_b32 v11, v11, v124
    v_or3_b32 v32, v32, v10, v11
    s_waitcnt vmcnt(0)
    v_xor_b32 v12, v12, v124
    v_xor_b32 v13, v13, v124
    v_or3_b32 v32, v32, v12, v13
    v_xor_b32 v14, v14, v124
    v_xor_b32 v15, v15, v124
    v_or3_b32 v32, v32, v14, v15
    v_and_b32 v32, 0x10001, v32
    v_cmp_ne_u32 vcc, 0, v32
    s_cbranch_scc1 FT_pgo
    s_cbranch_vccz FT_pgo
    s_sleep 2
    s_branch FT_px
FT_pgo:
    v_xor_b32 v124, 0x10001, v124
    v_mfma_f32_16x16x32_bf16 v[16:19], v[88:91], v[8:11], 0
    v_mfma_f32_16x16x32_bf16 v[20:23], v[92:95], v[8:11], 0
    v_mfma_f32_16x16x32_bf16 v[24:27], v[96:99], v[12:15], 0
    v_mfma_f32_16x16x32_bf16 v[28:31], v[100:103], v[12:15], 0
    s_nop 5
    v_cvt_pk_bf16_f32 v8, v16, v20
    v_cvt_pk_bf16_f32 v10, v17, v21
    v_cvt_pk_bf16_f32 v12, v18, v22
    v_cvt_pk_bf16_f32 v14, v19, v23
    v_cvt_pk_bf16_f32 v9, v24, v28
    v_cvt_pk_bf16_f32 v11, v25, v29
    v_cvt_pk_bf16_f32 v13, v26, v30
    v_cvt_pk_bf16_f32 v15, v27, v31
    ds_write_b64 v4, v[8:9] offset:0
    ds_write_b64 v4, v[10:11] offset:1024
    ds_write_b64 v4, v[12:13] offset:2048
    ds_write_b64 v4, v[14:15] offset:3072
    s_waitcnt lgkmcnt(0)
    s_barrier
    ds_read_b128 v[8:11], v6 offset:0
    ds_read_b128 v[12:15], v6 offset:1024
    s_waitcnt lgkmcnt(1)
    v_mfma_f32_16x16x32_bf16 v[16:19], v[80:83], v[8:11], 0
    v_mfma_f32_16x16x32_bf16 v[20:23], v[84:87], v[8:11], 0
    s_waitcnt lgkmcnt(0)
    v_mfma_f32_16x16x32_bf16 v[24:27], v[80:83], v[12:15], 0
    v_mfma_f32_16x16x32_bf16 v[28:31], v[84:87], v[12:15], 0
    s_nop 3
    v_mul_f32 v32, v16, v56
    v_mul_f32 v16, v16, v48
    v_mul_f32 v33, v17, v57
    v_mul_f32 v17, v17, v49
    v_mul_f32 v34, v18, v58
    v_mul_f32 v18, v18, v50
    v_mul_f32 v35, v19, v59
    v_mul_f32 v19, v19, v51
    v_fma_f32 v16, -v20, v56, v16
    v_fma_f32 v20, v20, v48, v32
    v_fma_f32 v17, -v21, v57, v17
    v_fma_f32 v21, v21, v49, v33
    v_fma_f32 v18, -v22, v58, v18
    v_fma_f32 v22, v22, v50, v34
    v_fma_f32 v19, -v23, v59, v19
    v_fma_f32 v23, v23, v51, v35
    v_cvt_pk_bf16_f32 v8, v20, v16
    v_cvt_pk_bf16_f32 v9, v21, v17
    v_cvt_pk_bf16_f32 v10, v22, v18
    v_cvt_pk_bf16_f32 v11, v23, v19
    s_nop 1
    v_mfma_f32_16x16x32_bf16 v[20:23], v[80:83], v[8:11], 0
    v_mfma_f32_16x16x32_bf16 v[16:19], v[84:87], v[8:11], 0
    v_mul_f32 v32, v24, v60
    v_mul_f32 v24, v24, v52
    v_mul_f32 v33, v25, v61
    v_mul_f32 v25, v25, v53
    v_mul_f32 v34, v26, v62
    v_mul_f32 v26, v26, v54
    v_mul_f32 v35, v27, v63
    v_mul_f32 v27, v27, v55
    v_fma_f32 v24, -v28, v60, v24
    v_fma_f32 v28, v28, v52, v32
    v_fma_f32 v25, -v29, v61, v25
    v_fma_f32 v29, v29, v53, v33
    v_fma_f32 v26, -v30, v62, v26
    v_fma_f32 v30, v30, v54, v34
    v_fma_f32 v27, -v31, v63, v27
    v_fma_f32 v31, v31, v55, v35
    v_cvt_pk_bf16_f32 v12, v28, v24
    v_cvt_pk_bf16_f32 v13, v29, v25
    v_cvt_pk_bf16_f32 v14, v30, v26
    v_cvt_pk_bf16_f32 v15, v31, v27
    s_nop 1
    v_mfma_f32_16x16x32_bf16 v[28:31], v[80:83], v[12:15], 0
    v_mfma_f32_16x16x32_bf16 v[24:27], v[84:87], v[12:15], 0
    v_cvt_pk_bf16_f32 v8, v20, v16
    v_cvt_pk_bf16_f32 v10, v21, v17
    v_cvt_pk_bf16_f32 v12, v22, v18
    v_cvt_pk_bf16_f32 v14, v23, v19
    s_nop 3
    v_cvt_pk_bf16_f32 v9, v28, v24
    v_cvt_pk_bf16_f32 v11, v29, v25
    v_cvt_pk_bf16_f32 v13, v30, v26
    v_cvt_pk_bf16_f32 v15, v31, v27
    ds_write_b64 v4, v[8:9] offset:19456
    ds_write_b64 v4, v[10:11] offset:20480
    ds_write_b64 v4, v[12:13] offset:21504
    ds_write_b64 v4, v[14:15] offset:22528
    s_waitcnt vmcnt(0) lgkmcnt(0)
    s_barrier
    ds_read_b128 v[8:11], v6 offset:19456
    ds_read_b128 v[12:15], v6 offset:20480
    s_waitcnt lgkmcnt(1)
    v_mfma_f32_16x16x32_bf16 v[20:23], v[104:107], v[8:11], 0
    v_mfma_f32_16x16x32_bf16 v[16:19], v[108:111], v[8:11], 0
    s_waitcnt lgkmcnt(0)
    v_mfma_f32_16x16x32_bf16 v[28:31], v[64:67], v[12:15], 0
    v_mfma_f32_16x16x32_bf16 v[24:27], v[68:71], v[12:15], 0
    s_nop 4
    v_cvt_pk_bf16_f32 v8, v20, v16
    v_cvt_pk_bf16_f32 v9, v21, v17
    v_cvt_pk_bf16_f32 v10, v22, v18
    v_cvt_pk_bf16_f32 v11, v23, v19
    v_and_or_b32 v8, v8, s35, v124
    global_store_dword v75, v8, s[60:61] offset:0 sc1
    v_and_or_b32 v9, v9, s35, v124
    global_store_dword v75, v9, s[60:61] offset:1024 sc1
    v_and_or_b32 v10, v10, s35, v124
    global_store_dword v75, v10, s[60:61] offset:2048 sc1
    v_and_or_b32 v11, v11, s35, v124
    global_store_dword v75, v11, s[60:61] offset:3072 sc1
    v_cvt_pk_bf16_f32 v12, v28, v24
    v_cvt_pk_bf16_f32 v13, v29, v25
    v_cvt_pk_bf16_f32 v14, v30, v26
    v_cvt_pk_bf16_f32 v15, v31, v27
    v_and_or_b32 v12, v12, s35, v124
    global_store_dword v75, v12, s[60:61] offset:128 sc1
    v_and_or_b32 v13, v13, s35, v124
    global_store_dword v75, v13, s[60:61] offset:1152 sc1
    v_and_or_b32 v14, v14, s35, v124
    global_store_dword v75, v14, s[60:61] offset:2176 sc1
    v_and_or_b32 v15, v15, s35, v124
    global_store_dword v75, v15, s[60:61] offset:3200 sc1
    s_cmp_lt_u32 s41, 128
    s_cbranch_scc1 B3_go
    s_endpgm
FT_idle:
    s_barrier
    s_barrier
    s_barrier
    s_endpgm
B3_go:
    ds_read_b128 v[108:111], v116 offset:33792
    ds_read_b128 v[112:115], v116 offset:34816
    v_add_u32 v7, 32768, v2
    s_lshl_b32 s45, s40, 8
    s_add_u32 s45, s45, s41
    s_lshl_b32 s51, s40, 3
    s_mul_i32 s47, s45, 2304
    s_add_u32 s47, s47, 1152
    s_add_u32 s4, s4, s47
    s_addc_u32 s5, s5, 0
    s_mul_i32 s47, s40, 2304
    s_add_u32 s47, s47, 58368
    s_cmp_lt_u32 s40, 3
    s_cselect_b32 s66, s65, s64
    s_lshr_b32 s67, s66, 3
    v_add_u32 v122, s67, v119
    v_cmp_gt_u32 vcc, 8, v1
    v_add_u32 v95, 294784, v2
    v_add_u32 v94, 1024, v2
    v_mov_b32 v123, v2
    v_cndmask_b32 v1, v95, v94, vcc
    ds_read_b128 v[84:87], v7 offset:22528
    ds_read_b128 v[88:91], v7 offset:23552
    ds_read_b128 v[92:95], v7 offset:24576
    ds_read_b128 v[8:11], v7 offset:3072
    ds_read_b128 v[12:15], v7 offset:4096
    ds_read_b128 v[16:19], v7 offset:5120
    ds_read_b128 v[20:23], v7 offset:6144
    ds_read_b128 v[24:27], v7 offset:7168
    ds_read_b128 v[28:31], v7 offset:8192
    ds_read_b128 v[32:35], v7 offset:9216
    ds_read_b128 v[36:39], v7 offset:10240
    ds_read_b128 v[48:51], v7 offset:13312
    ds_read_b128 v[52:55], v7 offset:14336
    ds_read_b128 v[40:43], v7 offset:11264
    ds_read_b128 v[44:47], v7 offset:12288
    s_waitcnt lgkmcnt(12)
    v_xor_b32 v84, s51, v84
    v_xor_b32 v85, s51, v85
    v_xor_b32 v86, s51, v86
    v_xor_b32 v87, s51, v87
    v_xor_b32 v88, s51, v88
    v_xor_b32 v89, s51, v89
    v_add_u32 v90, s47, v90
    v_add_u32 v91, s47, v91
    v_add_u32 v92, s47, v92
    v_add_u32 v93, s47, v93
    v_mov_b32 v94, v1
    v_mov_b32 v95, v123
    s_waitcnt lgkmcnt(0)
    s_sleep 26
B3_px:
    buffer_load_dword v96, v120, s[60:63], 0 offen sc1
    buffer_load_dword v97, v117, s[60:63], 0 offen sc1
    buffer_load_dword v98, v118, s[60:63], 0 offen sc1
    buffer_load_dword v99, v125, s[60:63], 0 offen sc1
    buffer_load_dword v100, v120, s[60:63], s64 offen sc1
    buffer_load_dword v101, v117, s[60:63], s64 offen sc1
    buffer_load_dword v102, v118, s[60:63], s64 offen sc1
    buffer_load_dword v103, v125, s[60:63], s64 offen sc1
    buffer_load_dword v104, v120, s[60:63], s66 offen sc1
    buffer_load_dword v105, v117, s[60:63], s66 offen sc1
    buffer_load_dword v106, v118, s[60:63], s66 offen sc1
    buffer_load_dword v107, v125, s[60:63], s66 offen sc1
    s_add_u32 s73, s73, 1
    s_cmp_gt_u32 s73, 3000
    s_waitcnt vmcnt(8)
    v_xor_b32 v96, v96, v124
    v_xor_b32 v97, v97, v124
    v_or_b32 v3, v96, v97
    v_xor_b32 v98, v98, v124
    v_xor_b32 v99, v99, v124
    v_or3_b32 v3, v3, v98, v99
    s_waitcnt vmcnt(4)
    v_xor_b32 v100, v100, v124
    v_xor_b32 v101, v101, v124
    v_or3_b32 v3, v3, v100, v101
    v_xor_b32 v102, v102, v124
    v_xor_b32 v103, v103, v124
    v_or3_b32 v3, v3, v102, v103
    s_waitcnt vmcnt(0)
    v_xor_b32 v104, v104, v124
    v_xor_b32 v105, v105, v124
    v_or3_b32 v3, v3, v104, v105
    v_xor_b32 v106, v106, v124
    v_xor_b32 v107, v107, v124
    v_or3_b32 v3, v3, v106, v107
    v_and_b32 v3, 0x10001, v3
    v_cmp_ne_u32 vcc, 0, v3
    s_cbranch_scc1 B3_pgo
    s_cbranch_vccz B3_pgo
    s_sleep 2
    s_branch B3_px
B3_pgo:
    v_mfma_f32_16x16x32_bf16 v[60:63], v[108:111], v[96:99], 0
    v_mfma_f32_16x16x32_bf16 v[56:59], v[112:115], v[96:99], 0
    v_mfma_f32_16x16x32_bf16 v[68:71], v[108:111], v[100:103], 0
    v_mfma_f32_16x16x32_bf16 v[64:67], v[112:115], v[100:103], 0
    v_mfma_f32_16x16x32_bf16 v[76:79], v[108:111], v[104:107], 0
    v_mfma_f32_16x16x32_bf16 v[72:75], v[112:115], v[104:107], 0
    s_nop 3
    v_cvt_pk_bf16_f32 v96, v56, v60
    v_cvt_pk_bf16_f32 v97, v57, v61
    v_cvt_pk_bf16_f32 v98, v58, v62
    v_cvt_pk_bf16_f32 v99, v59, v63
    ds_write_b128 v119, v[96:99] offset:0
    v_cvt_pk_bf16_f32 v100, v64, v68
    v_cvt_pk_bf16_f32 v101, v65, v69
    v_cvt_pk_bf16_f32 v102, v66, v70
    v_cvt_pk_bf16_f32 v103, v67, v71
    ds_write_b128 v119, v[100:103] offset:8192
    v_cvt_pk_bf16_f32 v104, v72, v76
    v_cvt_pk_bf16_f32 v105, v73, v77
    v_cvt_pk_bf16_f32 v106, v74, v78
    v_cvt_pk_bf16_f32 v107, v75, v79
    ds_write_b128 v122, v[104:107] offset:0
    ds_read_b128 v[56:59], v7 offset:15360
    ds_read_b128 v[60:63], v7 offset:16384
    ds_read_b128 v[64:67], v7 offset:17408
    ds_read_b128 v[68:71], v7 offset:18432
    ds_read_b128 v[72:75], v7 offset:19456
    ds_read_b128 v[76:79], v7 offset:20480
    ds_read_b128 v[80:83], v7 offset:21504
    s_waitcnt lgkmcnt(7)
    s_barrier
    ds_read_b64 v[112:113], v84 offset:0
    ds_read_b64 v[114:115], v85 offset:0
    ds_read_b64 v[116:117], v86 offset:0
    ds_read_b64 v[118:119], v87 offset:0
    ds_read_b64 v[120:121], v88 offset:0
    ds_read_b64 v[122:123], v89 offset:0
    s_waitcnt vmcnt(0)
    s_or_b32 s66, s41, s40
    s_cmp_eq_u32 s66, 0
    s_cbranch_scc0 B3_nn
    v_mov_b32 v6, 0
    v_mov_b32 v7, s34
    s_mov_b64 exec, 1
    global_store_dword v6, v7, s[32:33] sc1
    s_mov_b64 exec, -1
B3_nn:
    v_mov_b32 v106, 0
    v_mov_b32 v107, 0
    v_mov_b32 v110, 0
    v_mov_b32 v111, 0
    s_waitcnt lgkmcnt(2)
    v_mov_b32 v96, v112
    v_mov_b32 v97, v114
    v_mov_b32 v98, v116
    v_mov_b32 v99, v118
    v_mov_b32 v100, v113
    v_mov_b32 v101, v115
    v_mov_b32 v102, v117
    v_mov_b32 v103, v119
    s_waitcnt lgkmcnt(0)
    v_mov_b32 v104, v120
    v_mov_b32 v105, v122
    v_mov_b32 v108, v121
    v_mov_b32 v109, v123
    v_mfma_f32_16x16x32_bf16 v[112:115], v[96:99], v[8:11], 0
    v_mfma_f32_16x16x32_bf16 v[116:119], v[96:99], v[32:35], 0
    v_mfma_f32_16x16x32_bf16 v[112:115], v[104:107], v[12:15], v[112:115]
    v_mfma_f32_16x16x32_bf16 v[116:119], v[104:107], v[36:39], v[116:119]
    v_mfma_f32_16x16x32_bf16 v[120:123], v[100:103], v[8:11], 0
    v_mfma_f32_16x16x32_bf16 v[124:127], v[100:103], v[32:35], 0
    v_mfma_f32_16x16x32_bf16 v[120:123], v[108:111], v[12:15], v[120:123]
    v_mfma_f32_16x16x32_bf16 v[124:127], v[108:111], v[36:39], v[124:127]
    v_mfma_f32_16x16x32_bf16 v[0:3], v[96:99], v[16:19], 0
    s_nop 1
    v_mul_f32 v84, v112, v60
    v_mul_f32 v112, v112, v56
    v_mul_f32 v85, v113, v61
    v_mul_f32 v113, v113, v57
    v_mul_f32 v86, v114, v62
    v_mfma_f32_16x16x32_bf16 v[4:7], v[96:99], v[40:43], 0
    v_mul_f32 v114, v114, v58
    v_mul_f32 v87, v115, v63
    v_mul_f32 v115, v115, v59
    v_fma_f32 v112, -v116, v60, v112
    v_fma_f32 v116, v116, v56, v84
    v_mfma_f32_16x16x32_bf16 v[0:3], v[104:107], v[20:23], v[0:3]
    v_fma_f32 v113, -v117, v61, v113
    v_fma_f32 v117, v117, v57, v85
    v_fma_f32 v114, -v118, v62, v114
    v_fma_f32 v118, v118, v58, v86
    v_fma_f32 v115, -v119, v63, v115
    v_mfma_f32_16x16x32_bf16 v[4:7], v[104:107], v[44:47], v[4:7]
    v_fma_f32 v119, v119, v59, v87
    v_cvt_pk_bf16_f32 v8, v112, v116
    v_cvt_pk_bf16_f32 v9, v113, v117
    v_cvt_pk_bf16_f32 v10, v114, v118
    v_cvt_pk_bf16_f32 v11, v115, v119
    v_mfma_f32_16x16x32_bf16 v[0:3], v[100:103], v[24:27], v[0:3]
    v_mul_f32 v84, v120, v60
    v_mul_f32 v120, v120, v56
    v_mul_f32 v85, v121, v61
    v_mul_f32 v121, v121, v57
    v_mfma_f32_16x16x32_bf16 v[4:7], v[100:103], v[48:51], v[4:7]
    v_mul_f32 v86, v122, v62
    v_mul_f32 v122, v122, v58
    v_mul_f32 v87, v123, v63
    v_mul_f32 v123, v123, v59
    v_mfma_f32_16x16x32_bf16 v[0:3], v[108:111], v[28:31], v[0:3]
    v_fma_f32 v120, -v124, v60, v120
    v_fma_f32 v124, v124, v56, v84
    v_fma_f32 v121, -v125, v61, v121
    v_fma_f32 v125, v125, v57, v85
    v_mfma_f32_16x16x32_bf16 v[4:7], v[108:111], v[52:55], v[4:7]
    v_fma_f32 v122, -v126, v62, v122
    v_fma_f32 v126, v126, v58, v86
    v_fma_f32 v123, -v127, v63, v123
    v_fma_f32 v127, v127, v59, v87
    v_mfma_f32_16x16x32_bf16 v[96:99], v[8:11], v[72:75], 0
    v_cvt_pk_bf16_f32 v12, v120, v124
    v_cvt_pk_bf16_f32 v13, v121, v125
    v_cvt_pk_bf16_f32 v14, v122, v126
    v_cvt_pk_bf16_f32 v15, v123, v127
    v_mfma_f32_16x16x32_bf16 v[16:19], v[8:11], v[76:79], 0
    v_mul_f32 v84, v0, v68
    v_mul_f32 v0, v0, v64
    v_mul_f32 v85, v1, v69
    v_mul_f32 v1, v1, v65
    v_mul_f32 v86, v2, v70
    v_mul_f32 v2, v2, v66
    v_mfma_f32_16x16x32_bf16 v[20:23], v[12:15], v[72:75], 0
    v_mul_f32 v87, v3, v71
    v_mul_f32 v3, v3, v67
    v_fma_f32 v0, -v4, v68, v0
    v_fma_f32 v4, v4, v64, v84
    v_fma_f32 v1, -v5, v69, v1
    v_fma_f32 v5, v5, v65, v85
    v_fma_f32 v2, -v6, v70, v2
    v_mfma_f32_16x16x32_bf16 v[16:19], v[12:15], v[80:83], v[16:19]
    v_fma_f32 v6, v6, v66, v86
    v_fma_f32 v3, -v7, v71, v3
    v_fma_f32 v7, v7, v67, v87
    v_cvt_pk_bf16_f32 v32, v0, v4
    v_cvt_pk_bf16_f32 v33, v1, v5
    v_cvt_pk_bf16_f32 v34, v2, v6
    v_cvt_pk_bf16_f32 v35, v3, v7
    s_nop 1
    v_mfma_f32_16x16x32_bf16 v[24:27], v[32:35], v[72:75], 0
    v_mfma_f32_16x16x32_bf16 v[28:31], v[32:35], v[76:79], 0
    v_add_u32 v56, s47, v95
    v_add_u32 v57, 295808, v95
    v_cvt_pk_bf16_f32 v40, v96, v97
    v_cvt_pk_bf16_f32 v41, v98, v99
    ds_write_b64 v90, v[40:41] offset:0
    v_cvt_pk_bf16_f32 v42, v20, v21
    v_cvt_pk_bf16_f32 v43, v22, v23
    ds_write_b64 v90, v[42:43] offset:1152
    v_cvt_pk_bf16_f32 v44, v16, v17
    v_cvt_pk_bf16_f32 v45, v18, v19
    ds_write_b64 v92, v[44:45] offset:0
    v_cvt_pk_bf16_f32 v46, v24, v25
    v_cvt_pk_bf16_f32 v47, v26, v27
    ds_write_b64 v91, v[46:47] offset:0
    v_cvt_pk_bf16_f32 v48, v28, v29
    v_cvt_pk_bf16_f32 v49, v30, v31
    s_mov_b32 exec_lo, 0x00ff00ff
    s_mov_b32 exec_hi, 0x00ff00ff
    ds_write_b64 v93, v[48:49] offset:0
    s_mov_b64 exec, -1
    ds_read_b128 v[60:63], v56 offset:0
    ds_read_b128 v[64:67], v56 offset:1024
    ds_read_b128 v[68:71], v56 offset:2048
    s_waitcnt lgkmcnt(2)
    global_store_dwordx4 v95, v[60:63], s[4:5] sc1
    s_waitcnt lgkmcnt(1)
    global_store_dwordx4 v94, v[64:67], s[4:5] sc1
    s_mov_b64 exec, 0xffff
    s_waitcnt lgkmcnt(0)
    global_store_dwordx4 v57, v[68:71], s[4:5] sc1
    s_endpgm
RB_h:
    s_cmp_lt_u32 s41, 128
    s_cbranch_scc0 RB_hp
    s_setprio 3
    s_branch RB_hq
RB_hp:
    s_cmp_lt_u32 s40, 4
    s_cbranch_scc0 RB_hq
    v_add_u32 v8, 18432, v5
    global_load_dwordx4 v[100:103], v8, s[36:37]
    v_add_u32 v8, 22528, v5
    global_load_dwordx4 v[100:103], v8, s[36:37]
    v_add_u32 v8, 26624, v5
    global_load_dwordx4 v[100:103], v8, s[36:37]
    v_add_u32 v8, 30720, v5
    global_load_dwordx4 v[100:103], v8, s[36:37]
    v_add_u32 v8, 34816, v5
    global_load_dwordx4 v[100:103], v8, s[36:37]
    v_add_u32 v8, 36864, v5
    global_load_dwordx4 v[100:103], v8, s[36:37]
RB_hq:
    s_and_b32 s66, s41, 15
    s_lshr_b32 s67, s41, 4
    s_lshl_b32 s67, s67, 1
    s_lshr_b32 s68, s40, 2
    s_add_u32 s67, s67, s68
    s_and_b32 s69, s40, 3
    v_and_b32 v122, 15, v1
    v_lshrrev_b32 v121, 4, v1
    s_lshl_b32 s50, s69, 12
    s_add_u32 s50, s50, 38912
    v_add_u32 v7, s50, v2
    v_add_u32 v116, 45056, v2
    v_cvt_f32_u32 v36, v122
    v_lshlrev_b32 v37, 2, v121
    v_and_b32 v39, 4, v37
    v_cvt_f32_u32 v37, v37
    s_lshl_b32 s70, s69, 1
    v_cvt_f32_u32 v40, s70
    v_cvt_f32_u32 v41, s66
    s_mov_b32 s71, 0x41000000
    v_mul_f32 v41, 0x3a000000, v41
    v_mul_f32 v38, 0x3c000000, v36
    v_add_f32 v38, v38, v41
    v_mul_f32 v28, s71, v38
    v_mul_f32 v29, v40, v38
    v_add_f32 v30, v29, v38
    v_fma_f32 v38, v36, s71, v40
    v_mul_f32 v31, 0x3c000000, v38
    v_mul_f32 v32, v38, v41
    v_add_f32 v33, 0x3c000000, v31
    v_add_f32 v34, v32, v41
    v_fma_f32 v16, v28, v37, v29
    v_add_f32 v17, v16, v28
    v_fma_f32 v18, 2.0, v28, v16
    v_add_f32 v19, v18, v28
    v_cos_f32 v20, v16
    v_sin_f32 v24, v16
    v_cos_f32 v21, v17
    v_sin_f32 v25, v17
    v_cos_f32 v22, v18
    v_sin_f32 v26, v18
    v_cos_f32 v23, v19
    v_sin_f32 v27, v19
    v_cvt_pk_bf16_f32 v48, v20, v24
    v_cvt_pk_bf16_f32 v49, v21, v25
    v_cvt_pk_bf16_f32 v50, v22, v26
    v_cvt_pk_bf16_f32 v51, v23, v27
    ds_write_b128 v7, v[48:51] offset:0
    v_fma_f32 v16, v28, v37, v30
    v_add_f32 v17, v16, v28
    v_fma_f32 v18, 2.0, v28, v16
    v_add_f32 v19, v18, v28
    v_cos_f32 v20, v16
    v_sin_f32 v24, v16
    v_cos_f32 v21, v17
    v_sin_f32 v25, v17
    v_cos_f32 v22, v18
    v_sin_f32 v26, v18
    v_cos_f32 v23, v19
    v_sin_f32 v27, v19
    v_cvt_pk_bf16_f32 v52, v20, v24
    v_cvt_pk_bf16_f32 v53, v21, v25
    v_cvt_pk_bf16_f32 v54, v22, v26
    v_cvt_pk_bf16_f32 v55, v23, v27
    ds_write_b128 v7, v[52:55] offset:1024
    v_fma_f32 v16, v31, v37, v32
    v_add_f32 v17, v16, v31
    v_fma_f32 v18, 2.0, v31, v16
    v_add_f32 v19, v18, v31
    v_cos_f32 v20, v16
    v_sin_f32 v24, v16
    v_cos_f32 v21, v17
    v_sin_f32 v25, v17
    v_cos_f32 v22, v18
    v_sin_f32 v26, v18
    v_cos_f32 v23, v19
    v_sin_f32 v27, v19
    v_cvt_pk_bf16_f32 v56, v20, v24
    v_cvt_pk_bf16_f32 v57, v21, v25
    v_cvt_pk_bf16_f32 v58, v22, v26
    v_cvt_pk_bf16_f32 v59, v23, v27
    ds_write_b128 v7, v[56:59] offset:2048
    v_fma_f32 v16, v33, v37, v34
    v_add_f32 v17, v16, v33
    v_fma_f32 v18, 2.0, v33, v16
    v_add_f32 v19, v18, v33
    v_cos_f32 v20, v16
    v_sin_f32 v24, v16
    v_cos_f32 v21, v17
    v_sin_f32 v25, v17
    v_cos_f32 v22, v18
    v_sin_f32 v26, v18
    v_cos_f32 v23, v19
    v_sin_f32 v27, v19
    v_cvt_pk_bf16_f32 v60, v20, v24
    v_cvt_pk_bf16_f32 v61, v21, v25
    v_cvt_pk_bf16_f32 v62, v22, v26
    v_cvt_pk_bf16_f32 v63, v23, v27
    ds_write_b128 v7, v[60:63] offset:3072
    s_bitcmp1_b32 s40, 0
    s_cbranch_scc1 RB_f16
    v_and_b32 v28, 7, v122
    v_cvt_f32_u32 v28, v28
    v_cvt_f32_u32 v37, v39
    v_mul_f32 v28, 0x3e000000, v28
    v_lshrrev_b32 v29, 3, v122
    v_lshrrev_b32 v30, 1, v121
    v_cmp_eq_u32 vcc, v29, v30
    v_mov_b32 v31, v116
    s_branch RB_f
RB_f16:
    v_mul_f32 v28, 0x3d800000, v36
    s_mov_b64 vcc, -1
    v_add_u32 v31, 1024, v116
RB_f:
    v_mul_f32 v16, v28, v37
    v_add_f32 v17, v16, v28
    v_fma_f32 v18, 2.0, v28, v16
    v_add_f32 v19, v18, v28
    v_cos_f32 v20, v16
    v_sin_f32 v24, v16
    v_cos_f32 v21, v17
    v_sin_f32 v25, v17
    v_cos_f32 v22, v18
    v_sin_f32 v26, v18
    v_cos_f32 v23, v19
    v_sin_f32 v27, v19
    v_cvt_pk_bf16_f32 v64, v20, v24
    v_cvt_pk_bf16_f32 v65, v21, v25
    v_cvt_pk_bf16_f32 v66, v22, v26
    v_cvt_pk_bf16_f32 v67, v23, v27
    v_cvt_pk_bf16_f32 v68, -v24, v20
    v_cvt_pk_bf16_f32 v69, -v25, v21
    v_cvt_pk_bf16_f32 v70, -v26, v22
    v_cvt_pk_bf16_f32 v71, -v27, v23
    v_cndmask_b32 v64, 0, v64, vcc
    v_cndmask_b32 v65, 0, v65, vcc
    v_cndmask_b32 v66, 0, v66, vcc
    v_cndmask_b32 v67, 0, v67, vcc
    ds_write_b128 v31, v[64:67] offset:32768
    s_bitcmp1_b32 s40, 0
    s_cbranch_scc0 RB_f2
    ds_write_b128 v31, v[68:71] offset:33792
RB_f2:
    s_waitcnt lgkmcnt(0)
    s_cmp_lt_u32 s41, 128
    s_cbranch_scc0 RB_w
    s_barrier
    s_barrier
RB_w:
    s_mov_b32 s52, s28
    s_mov_b32 s53, s29
    s_mov_b32 s54, 1183748
    s_mov_b32 s55, 0x20000
    s_load_dword s34, s[32:33], s75
    s_mov_b64 s[24:25], s[30:31]
    s_mov_b32 s26, 1183748
    s_mov_b32 s27, 0x20000
    s_lshl_b32 s70, s69, 9
    s_add_u32 s70, s70, s66
    s_mul_i32 s70, s70, 578
    s_lshr_b32 s71, s41, 4
    s_lshl_b32 s71, s71, 6
    s_add_u32 s70, s70, s71
    v_lshrrev_b32 v8, 2, v1
    v_mul_u32_u24 v8, 9248, v8
    v_and_b32 v9, 3, v1
    v_lshl_add_u32 v8, v9, 4, v8
    s_lshl_b32 s71, s69, 11
    s_add_u32 m0, s71, 58368
    v_add_u32 v8, s70, v8
    s_mov_b32 s70, 147968
    s_cmp_eq_u32 s68, 0
    s_cbranch_scc1 RB_nw
    buffer_load_dwordx4 v8, s[52:55], 0 offen lds
    s_add_u32 m0, m0, 1024
    s_nop 0
    buffer_load_dwordx4 v8, s[52:55], s70 offen lds
    s_add_u32 m0, m0, 7168
    s_nop 0
    buffer_load_dwordx4 v8, s[24:27], 0 offen lds
    s_add_u32 m0, m0, 1024
    s_nop 0
    buffer_load_dwordx4 v8, s[24:27], s70 offen lds
RB_nw:
    s_cmp_lt_u32 s41, 128
    s_cbranch_scc0 RB_l
    s_add_u32 s56, s32, 4096
    s_addc_u32 s57, s33, 0
    s_mov_b32 s58, 2621440
    s_mov_b32 s59, 0x20000
    s_add_u32 s60, s32, 4096
    s_addc_u32 s61, s33, 0
    s_mov_b32 s62, 2621440
    s_mov_b32 s63, 0x20000
    s_mov_b32 s64, 65536
    s_mov_b32 s65, 131072
    s_mov_b32 s49, 655360
    v_mul_lo_u32 v120, v121, s49
    v_lshl_add_u32 v120, v122, 2, v120
    s_lshl_b32 s49, s41, 7
    s_lshr_b32 s50, s40, 1
    s_lshl_b32 s50, s50, 14
    s_add_u32 s49, s49, s50
    s_and_b32 s50, s40, 1
    s_lshl_b32 s50, s50, 6
    s_add_u32 s49, s49, s50
    v_add_u32 v120, s49, v120
    v_add_u32 v117, 163840, v120
    v_add_u32 v118, 327680, v120
    v_add_u32 v125, 491520, v120
    v_lshrrev_b32 v119, 2, v122
    v_xor_b32 v119, v119, v121
    v_lshlrev_b32 v119, 4, v119
    v_lshl_add_u32 v119, v122, 6, v119
    v_add_u32 v119, s48, v119
    v_lshlrev_b32 v124, 1, v122
    s_mov_b32 s35, 0xfffefffe
    s_waitcnt lgkmcnt(0)
    s_add_u32 s34, s34, 0x9e3779b9
    v_bfe_u32 v124, s34, v124, 2
    v_lshl_or_b32 v124, v124, 15, v124
    v_and_b32 v124, 0x10001, v124
    ds_read_b128 v[8:11], v116 offset:33792
    ds_read_b128 v[12:15], v116 offset:34816
    s_branch B1_rg
RB_l:
    s_add_u32 s56, s32, 4096
    s_addc_u32 s57, s33, 0
    s_mov_b32 s58, 2621440
    s_mov_b32 s59, 0x20000
    s_add_u32 s60, s32, 4096
    s_addc_u32 s61, s33, 0
    s_mov_b32 s62, 2621440
    s_mov_b32 s63, 0x20000
    s_mov_b32 s64, 65536
    s_mov_b32 s65, 131072
    s_mov_b32 s49, 655360
    v_mul_lo_u32 v120, v121, s49
    v_lshl_add_u32 v120, v122, 2, v120
    s_lshl_b32 s49, s41, 7
    s_lshr_b32 s50, s40, 1
    s_lshl_b32 s50, s50, 14
    s_add_u32 s49, s49, s50
    s_and_b32 s50, s40, 1
    s_lshl_b32 s50, s50, 6
    s_add_u32 s49, s49, s50
    v_add_u32 v120, s49, v120
    v_add_u32 v117, 163840, v120
    v_add_u32 v118, 327680, v120
    v_add_u32 v125, 491520, v120
    v_lshrrev_b32 v119, 2, v122
    v_xor_b32 v119, v119, v121
    v_lshlrev_b32 v119, 4, v119
    v_lshl_add_u32 v119, v122, 6, v119
    v_add_u32 v119, s48, v119
    v_lshlrev_b32 v124, 1, v122
    s_mov_b32 s35, 0xfffefffe
    s_waitcnt lgkmcnt(0)
    s_add_u32 s34, s34, 0x9e3779b9
    v_bfe_u32 v124, s34, v124, 2
    v_lshl_or_b32 v124, v124, 15, v124
    v_and_b32 v124, 0x10001, v124
    s_waitcnt vmcnt(0)
    s_barrier
    ds_read_b128 v[80:83], v116 offset:32768
    ds_read_b128 v[88:91], v7 offset:0
    ds_read_b128 v[96:99], v7 offset:1024
    ds_read_b128 v[104:107], v7 offset:2048
    ds_read_b128 v[64:67], v7 offset:3072
    s_sleep 23
    s_branch B1_done
EXIT:
    s_endpgm
CODE_END:
.p2align 8
TAB_B1:
.long 0x3f803f80,0x3f803f80,0x3f803f80,0x3f803f80,0x3f773f80,0x3f353f5e,0xbe85bf00,0x3e85a554,0x3f5e3f80,0x248d3f00,0xbf5ebf00,0xbf5ebf80,0x3f353f80,0xbf35248d,0x3f353f80,0xbf35261f
.long 0x3f003f80,0xbf80bf00,0x3f00bf00,0x3f003f80,0x3e853f80,0xbf35bf5e,0xbf77bf00,0x3f77a742,0x248d3f80,0xa554bf80,0xa6543f80,0xa754bf80,0xbe853f80,0x3f35bf5e,0x3f77bf00,0xbf77a60d
.long 0xbf003f80,0x3f80bf00,0xbf00bf00,0xbf003f80,0xbf353f80,0x3f35a554,0xbf353f80,0x3f35a777,0xbf5e3f80,0x25b03f00,0x3f5ebf00,0x3f5ebf80,0xbf773f80,0xbf353f5e,0x3e85bf00,0xbe85258d
.long 0xbf803f80,0xbf803f80,0xbf803f80,0xbf803f80,0xbf773f80,0xbf353f5e,0x3e85bf00,0xbe85a796,0xbf5e3f80,0xa5f73f00,0x3f5ebf00,0x3f5ebf80,0xbf353f80,0x3f3525b0,0xbf353f80,0x3f35268d
.long 0x3f803f80,0x3f803f80,0x3f803f80,0x3f803f80,0x3e853f00,0xbe85248d,0x3f353f00,0x3f773f5e,0xbf5ebf00,0xbf5ebf80,0xa5f7bf00,0x3f5e3f00,0xbf35bf80,0x3f35a554,0xbf35bf80,0x3f35a731
.long 0x3f00bf00,0x3f003f80,0xbf80bf00,0x3f00bf00,0x3f773f00,0xbf7725b0,0xbf353f00,0x3e85bf5e,0x25b03f80,0xa5f7bf80,0xa60d3f80,0xa765bf80,0xbf773f00,0x3f77a5f7,0x3f353f00,0xbe85bf5e
.long 0xbf00bf00,0xbf003f80,0x3f80bf00,0xbf00bf00,0x3f35bf80,0xbf35261f,0x3f35bf80,0xbf35258d,0x3f5ebf00,0x3f5ebf80,0xa78dbf00,0xbf5e3f00,0xbe853f00,0x3e85a731,0xbf353f00,0xbf773f5e
.long 0xbf803f80,0xbf803f80,0xbf803f80,0xbf803f80,0xbe853f00,0x3e85a68d,0xbf353f00,0xbf773f5e,0x3f5ebf00,0x3f5ebf80,0x2816bf00,0xbf5e3f00,0x3f35bf80,0xbf35a742,0x3f35bf80,0xbf35270d
.long 0x3f803f80,0x3f803f80,0x0,0x0,0xbf35bf00,0xbf77bf5e,0x80008000,0x8000,0xa554bf00,0x3f5e3f00,0x80008000,0x80008000,0x3f353f80,0xbf3525b0,0x0,0x80000000
.long 0xbf80bf00,0x3f00bf00,0x8000,0x0,0x3f35bf00,0xbe853f5e,0x80008000,0x8000,0x261f3f80,0xa731bf80,0x80000000,0x80008000,0xbf35bf00,0x3e853f5e,0x8000,0x80008000
.long 0x3f80bf00,0xbf00bf00,0x80008000,0x80000000,0xbf353f80,0x3f35a742,0x80000000,0x8000,0xa742bf00,0xbf5e3f00,0x8000,0x8000,0x3f35bf00,0x3f77bf5e,0x8000,0x80000000
.long 0xbf803f80,0xbf803f80,0x80000000,0x80000000,0x3f35bf00,0x3f77bf5e,0x8000,0x80008000,0xa60dbf00,0xbf5e3f00,0x8000,0x8000,0xbf353f80,0x3f35a58e,0x80000000,0x0
.long 0x3f803f80,0x3f803f80,0x0,0x0,0xbf77bf80,0xbf35bf5e,0x0,0x0,0x3f5e3f80,0x25b03f00,0x80008000,0x0,0xbf35bf80,0x3f35a5f7,0x80008000,0x8000
.long 0x3f003f80,0xbf80bf00,0x80008000,0x8000,0xbe85bf80,0x3f353f5e,0x80000000,0x8000,0xa68d3f80,0xa742bf80,0x80000000,0x80008000,0x3e85bf80,0xbf353f5e,0x0,0x80008000
.long 0xbf003f80,0x3f80bf00,0x8000,0x80008000,0x3f35bf80,0xbf35a60d,0x8000,0x80000000,0xbf5e3f80,0xa58e3f00,0x80008000,0x80000000,0x3f77bf80,0x3f35bf5e,0x80000000,0x80000000
.long 0xbf803f80,0xbf803f80,0x80000000,0x80000000,0x3f77bf80,0x3f35bf5e,0x80000000,0x80000000,0xbf5e3f80,0xa78d3f00,0x8000,0x80000000,0x3f35bf80,0xbf35a78d,0x8000,0x80000000
.long 0x80008000,0x80008000,0x80008000,0x80008000,0xbe858000,0xbf35bf00,0x3f773f5e,0x3f773f80,0xbf008000,0xbf80bf5e,0xbf00bf5e,0x3f00a5d4,0xbf358000,0xbf35bf80,0xbf35260d,0xbf35bf80
.long 0xbf5e8000,0xa50dbf5e,0x3f5e3f5e,0xbf5e2654,0xbf778000,0x3f35bf00,0x3e85bf5e,0x3e853f80,0xbf808000,0x3f80a50d,0xbf80268d,0x3f80a69f,0xbf778000,0x3f353f00,0x3e853f5e,0x3e85bf80
.long 0xbf5e8000,0x258d3f5e,0x3f5ebf5e,0xbf5e26d4,0xbf358000,0xbf353f80,0xbf3526d4,0xbf353f80,0xbf008000,0xbf803f5e,0xbf003f5e,0x3f00a7c2,0xbe858000,0xbf353f00,0x3f77bf5e,0x3f77bf80
.long 0xa50d8000,0xa5d4258d,0x26d4270d,0xa7d4271f,0x3e858000,0x3f35bf00,0xbf773f5e,0xbf773f80,0x3f008000,0x3f80bf5e,0x3f00bf5e,0xbf00268d,0x3f358000,0x3f35bf80,0x3f352730,0x3f35bf80
.long 0x80008000,0x80008000,0x80008000,0x80008000,0xbf77bf5e,0xbf77bf80,0x3f353f5e,0x3e853f00,0xbf00bf5e,0x3f00a50d,0x3f803f5e,0x3f003f5e,0x3f35a50d,0x3f353f80,0x3f35a630,0x3f353f80
.long 0x3f5e3f5e,0xbf5e258d,0xa677bf5e,0x3f5e3f5e,0xbe853f5e,0xbe85bf80,0xbf35bf5e,0x3f773f00,0xbf80258d,0x3f80a5d4,0xbf8026b0,0x3f80a7b1,0xbe85bf5e,0xbe853f80,0xbf353f5e,0x3f77bf00
.long 0x3f5ebf5e,0xbf5e260d,0x26f73f5e,0x3f5ebf5e,0x3f35a5d4,0x3f35bf80,0x3f35a7c2,0x3f35bf80,0xbf003f5e,0x3f00a630,0x3f80bf5e,0x3f00bf5e,0xbf773f5e,0xbf773f80,0x3f35bf5e,0x3e85bf00
.long 0xa630260d,0xa6772654,0x268d2730,0xa7e52831,0x3f77bf5e,0x3f77bf80,0xbf353f5e,0xbe853f00,0x3f00bf5e,0xbf00a677,0xbf803f5e,0xbf003f5e,0xbf35a630,0xbf353f80,0xbf35260e,0xbf353f80
.long 0x80008000,0x80008000,0x80008000,0x80008000,0xbf35bf5e,0xbe85bf00,0x0,0x0,0x3f803f5e,0x3f003f5e,0x80008000,0x8000,0xbf35258d,0xbf35bf80,0x80000000,0x80008000
.long 0xa5d4bf5e,0x3f5e3f5e,0x0,0x80000000,0x3f353f5e,0xbf77bf00,0x8000,0x0,0xbf80260d,0x3f80a630,0x80000000,0x8000,0x3f35bf5e,0xbf773f00,0x0,0x8000
.long 0x26543f5e,0x3f5ebf5e,0x8000,0x80000000,0xbf352654,0xbf353f80,0x80000000,0x80000000,0x3f80bf5e,0x3f00bf5e,0x80000000,0x8000,0xbf353f5e,0xbe853f00,0x8000,0x8000
.long 0xa69f268d,0xa7b126b0,0x0,0x80000000,0x3f35bf5e,0x3e85bf00,0x80000000,0x80000000,0xbf803f5e,0xbf003f5e,0x8000,0x80000000,0x3f3526b0,0x3f35bf80,0x0,0x8000
.long 0x80008000,0x80008000,0x80008000,0x80008000,0x3e85a50d,0x3f353f00,0x0,0x0,0xbf00258d,0xbf80bf5e,0x0,0x0,0x3f35a5d4,0x3f353f80,0x8000,0x0
.long 0xbf5e260d,0xa630bf5e,0x80008000,0x0,0x3f77a630,0xbf353f00,0x80008000,0x0,0xbf802654,0x3f80a677,0x80000000,0x8000,0x3f77a677,0xbf35bf00,0x80000000,0x8000
.long 0xbf5e268d,0x26b03f5e,0x0,0x8000,0x3f35a69f,0x3f35bf80,0x8000,0x8000,0xbf0026b0,0xbf803f5e,0x8000,0x8000,0x3e85a7b1,0x3f35bf00,0x8000,0x8000
.long 0x270d26d4,0xa7c226f7,0x0,0x80000000,0xbe85270d,0xbf353f00,0x80000000,0x80000000,0x3f0026f7,0x3f80bf5e,0x80000000,0x80000000,0xbf35a7c2,0xbf353f80,0x80000000,0x80000000
.long 0x3f800000,0x3f800000,0x3f800000,0x3f800000,0x3f800000,0x3f7ffc1a,0x3f7ff067,0x3f7fdce9,0x3f800000,0x3f7ff067,0x3f7fc1a0,0x3f7f73af,0x3f800000,0x3f7fdce9,0x3f7f73af,0x3f7ec46d
.long 0x3f800000,0x3f7fc1a0,0x3f7f069e,0x3f7dcf55,0x3f800000,0x3f7f9e8c,0x3f7e7a7a,0x3f7c94a8,0x3f800000,0x3f7f73af,0x3f7dcf55,0x3f7b14be,0x3f800000,0x3f7f4109,0x3f7d0543,0x3f795000
.long 0x3f800000,0x3f7f069e,0x3f7c1c5c,0x3f7746ea,0x3f800000,0x3f7ec46d,0x3f7b14be,0x3f74fa0b,0x3f800000,0x3f7e7a7a,0x3f79ee89,0x3f726a03,0x3f800000,0x3f7e28c6,0x3f78a9e0,0x3f6f9788
.long 0x3f800000,0x3f7dcf55,0x3f7746ea,0x3f6c835e,0x3f800000,0x3f7d6e28,0x3f75c5d4,0x3f692e5f,0x3f800000,0x3f7d0543,0x3f7426cb,0x3f659974,0x3f800000,0x3f7c94a8,0x3f726a03,0x3f61c598
.long 0x3f800000,0x3f800000,0x3f800000,0x3f800000,0x3f7fc1a0,0x3f7f9e8c,0x3f7f73af,0x3f7f4109,0x3f7f069e,0x3f7e7a7a,0x3f7dcf55,0x3f7d0543,0x3f7dcf55,0x3f7c94a8,0x3f7b14be,0x3f795000
.long 0x3f7c1c5c,0x3f79ee89,0x3f7746ea,0x3f7426cb,0x3f79ee89,0x3f768a20,0x3f726a03,0x3f6d9156,0x3f7746ea,0x3f726a03,0x3f6c835e,0x3f659974,0x3f7426cb,0x3f6d9156,0x3f659974,0x3f5c4b07
.long 0x3f708fb2,0x3f6803ca,0x3f5db3d7,0x3f51b3f3,0x3f6c835e,0x3f61c598,0x3f54db31,0x3f45e403,0x3f6803ca,0x3f5adb81,0x3f4b1934,0x3f38ecd8,0x3f631324,0x3f534aca,0x3f407893,0x3f2ae1c9
.long 0x3f5db3d7,0x3f4b1934,0x3f3504f3,0x3f1bd7ca,0x3f57e880,0x3f424cfe,0x3f28cae3,0x3f0be54a,0x3f51b3f3,0x3f38ecd8,0x3f1bd7ca,0x3ef64429,0x3f4b1934,0x3f2effe8,0x3f0e39da,0x3ed34e56
.long 0x3f800000,0x3f800000,0x3f800000,0x3f800000,0x3f7f069e,0x3f7ec46d,0x3f7e7a7a,0x3f7e28c6,0x3f7c1c5c,0x3f7b14be,0x3f79ee89,0x3f78a9e0,0x3f7746ea,0x3f74fa0b,0x3f726a03,0x3f6f9788
.long 0x3f708fb2,0x3f6c835e,0x3f6803ca,0x3f631324,0x3f6803ca,0x3f61c598,0x3f5adb81,0x3f534aca,0x3f5db3d7,0x3f54db31,0x3f4b1934,0x3f407893,0x3f51b3f3,0x3f45e403,0x3f38ecd8,0x3f2ae1c9
.long 0x3f441b7d,0x3f3504f3,0x3f248dbb,0x3f12d5e8,0x3f3504f3,0x3f226799,0x3f0e39da,0x3ef15aea,0x3f248dbb,0x3f0e39da,0x3eec6a50,0x3eb9917b,0x3f12d5e8,0x3ef15aea,0x3eb9917b,0x3e7e39c4
.long 0x3f000000,0x3ec3ef15,0x3e8483ee,0x3e05a8a8,0x3ed8616c,0x3e94a031,0x3e1bc63c,0x3c32b7da,0x3eaf1d44,0x3e47c5c2,0x3d32aa3e,0xbddef599,0x3e8483ee,0x3dc8bd36,0xbd85f213,0xbe6886ae
.long 0x3f800000,0x3f800000,0x3f800000,0x3f800000,0x3f7dcf55,0x3f7d6e28,0x3f7d0543,0x3f7c94a8,0x3f7746ea,0x3f75c5d4,0x3f7426cb,0x3f726a03,0x3f6c835e,0x3f692e5f,0x3f659974,0x3f61c598
.long 0x3f5db3d7,0x3f57e880,0x3f51b3f3,0x3f4b1934,0x3f4b1934,0x3f424cfe,0x3f38ecd8,0x3f2effe8,0x3f3504f3,0x3f28cae3,0x3f1bd7ca,0x3f0e39da,0x3f1bd7ca,0x3f0be54a,0x3ef64429,0x3ed34e56
.long 0x3f000000,0x3ed8616c,0x3eaf1d44,0x3e8483ee,0x3ec3ef15,0x3e94a031,0x3e47c5c2,0x3dc8bd36,0x3e8483ee,0x3e1bc63c,0x3d32aa3e,0xbd85f213,0x3e05a8a8,0x3c32b7da,0xbddef599,0xbe6886ae
.long 0x248d3132,0xbe05a8a8,0xbe8483ee,0xbec3ef15,0xbe05a8a8,0xbe89e6f1,0xbece34d0,0xbf072f74,0xbe8483ee,0xbece34d0,0xbf098c78,0xbf28cae3,0xbec3ef15,0xbf072f74,0xbf28cae3,0xbf45e403
.long 0x80000000,0x80000000,0x80000000,0x80000000,0x80000000,0xbc32b7da,0xbcb2b521,0xbd060472,0x80000000,0xbcb2b521,0xbd32aa3e,0xbd85f213,0x80000000,0xbd060472,0xbd85f213,0xbdc8bd36
.long 0x80000000,0xbd32aa3e,0xbdb27eb6,0xbe05a8a8,0x80000000,0xbd5f4a99,0xbddef599,0xbe26ce12,0x80000000,0xbd85f213,0xbe05a8a8,0xbe47c5c2,0x80000000,0xbd9c3ac6,0xbe1bc63c,0xbe6886ae
.long 0x80000000,0xbdb27eb6,0xbe31d0d4,0xbe8483ee,0x80000000,0xbdc8bd36,0xbe47c5c2,0xbe94a031,0x80000000,0xbddef599,0xbe5da259,0xbea493b7,0x80000000,0xbdf52731,0xbe7363ee,0xbeb45a1e
.long 0x80000000,0xbe05a8a8,0xbe8483ee,0xbec3ef15,0x80000000,0xbe10b9a6,0xbe8f45c0,0xbed34e56,0x80000000,0xbe1bc63c,0xbe99f61c,0xbee273aa,0x80000000,0xbe26ce12,0xbea493b7,0xbef15aea
.long 0x80000000,0x80000000,0x80000000,0x80000000,0xbd32aa3e,0xbd5f4a99,0xbd85f213,0xbd9c3ac6,0xbdb27eb6,0xbddef599,0xbe05a8a8,0xbe1bc63c,0xbe05a8a8,0xbe26ce12,0xbe47c5c2,0xbe6886ae
.long 0xbe31d0d4,0xbe5da259,0xbe8483ee,0xbe99f61c,0xbe5da259,0xbe89e6f1,0xbea493b7,0xbebec330,0xbe8483ee,0xbea493b7,0xbec3ef15,0xbee273aa,0xbe99f61c,0xbebec330,0xbee273aa,0xbf026926
.long 0xbeaf1d44,0xbed8616c,0xbf000000,0xbf12d5e8,0xbec3ef15,0xbef15aea,0xbf0e39da,0xbf226799,0xbed8616c,0xbf04ce53,0xbf1bd7ca,0xbf310700,0xbeec6a50,0xbf108a14,0xbf28cae3,0xbf3e9e4b
.long 0xbf000000,0xbf1bd7ca,0xbf3504f3,0xbf4b1934,0xbf098c78,0xbf26aed9,0xbf407893,0xbf56651d,0xbf12d5e8,0xbf310700,0xbf4b1934,0xbf60712a,0xbf1bd7ca,0xbf3ad85f,0xbf54db31,0xbf692e5f
.long 0x80000000,0x80000000,0x80000000,0x80000000,0xbdb27eb6,0xbdc8bd36,0xbddef599,0xbdf52731,0xbe31d0d4,0xbe47c5c2,0xbe5da259,0xbe7363ee,0xbe8483ee,0xbe94a031,0xbea493b7,0xbeb45a1e
.long 0xbeaf1d44,0xbec3ef15,0xbed8616c,0xbeec6a50,0xbed8616c,0xbef15aea,0xbf04ce53,0xbf108a14,0xbf000000,0xbf0e39da,0xbf1bd7ca,0xbf28cae3,0xbf12d5e8,0xbf226799,0xbf310700,0xbf3e9e4b
.long 0xbf248dbb,0xbf3504f3,0xbf441b7d,0xbf51b3f3,0xbf3504f3,0xbf45e403,0xbf54db31,0xbf61c598,0xbf441b7d,0xbf54db31,0xbf631324,0xbf6e9811,0xbf51b3f3,0xbf61c598,0xbf6e9811,0xbf77fc2c
.long 0xbf5db3d7,0xbf6c835e,0xbf7746ea,0xbf7dcf55,0xbf6803ca,0xbf74fa0b,0xbf7d0543,0xbf7ffc1a,0xbf708fb2,0xbf7b14be,0xbf7fc1a0,0xbf7e7a7a,0xbf7746ea,0xbf7ec46d,0xbf7f73af,0xbf795000
.long 0x80000000,0x80000000,0x80000000,0x80000000,0xbe05a8a8,0xbe10b9a6,0xbe1bc63c,0xbe26ce12,0xbe8483ee,0xbe8f45c0,0xbe99f61c,0xbea493b7,0xbec3ef15,0xbed34e56,0xbee273aa,0xbef15aea
.long 0xbf000000,0xbf098c78,0xbf12d5e8,0xbf1bd7ca,0xbf1bd7ca,0xbf26aed9,0xbf310700,0xbf3ad85f,0xbf3504f3,0xbf407893,0xbf4b1934,0xbf54db31,0xbf4b1934,0xbf56651d,0xbf60712a,0xbf692e5f
.long 0xbf5db3d7,0xbf6803ca,0xbf708fb2,0xbf7746ea,0xbf6c835e,0xbf74fa0b,0xbf7b14be,0xbf7ec46d,0xbf7746ea,0xbf7d0543,0xbf7fc1a0,0xbf7f73af,0xbf7dcf55,0xbf7ffc1a,0xbf7e7a7a,0xbf795000
.long 0xbf800000,0xbf7dcf55,0xbf7746ea,0xbf6c835e,0xbf7dcf55,0xbf768a20,0xbf6a51da,0xbf596550,0xbf7746ea,0xbf6a51da,0xbf57e880,0xbf407893,0xbf6c835e,0xbf596550,0xbf407893,0xbf226799
.long 0x3f800000,0x3f800000,0x3f800000,0x3f800000,0x3f7c1c5c,0x3f7b9c62,0x3f7b14be,0x3f7a8575,0x3f708fb2,0x3f6e9811,0x3f6c835e,0x3f6a51da,0x3f5db3d7,0x3f596550,0x3f54db31,0x3f5016b8
.long 0x3f441b7d,0x3f3cbe35,0x3f3504f3,0x3f2cf37b,0x3f248dbb,0x3f199e45,0x3f0e39da,0x3f026926,0x3f000000,0x3ee273aa,0x3ec3ef15,0x3ea493b7,0x3eaf1d44,0x3e89e6f1,0x3e47c5c2,0x3df52731
.long 0x3e31d0d4,0x3db27eb6,0x248d3132,0xbdb27eb6,0x248d3132,0xbdc8bd36,0xbe47c5c2,0xbe94a031,0xbe31d0d4,0xbe8f45c0,0xbec3ef15,0xbef64429,0xbeaf1d44,0xbee77284,0xbf0e39da,0xbf26aed9
.long 0xbf000000,0xbf1bd7ca,0xbf3504f3,0xbf4b1934,0xbf248dbb,0xbf3e9e4b,0xbf54db31,0xbf66d223,0xbf441b7d,0xbf5adb81,0xbf6c835e,0xbf78a9e0,0xbf5db3d7,0xbf6f9788,0xbf7b14be,0xbf7fdce9
.long 0x3f800000,0x3f800000,0x3f800000,0x3f800000,0x3f79ee89,0x3f795000,0x3f78a9e0,0x3f77fc2c,0x3f6803ca,0x3f659974,0x3f631324,0x3f60712a,0x3f4b1934,0x3f45e403,0x3f407893,0x3f3ad85f
.long 0x3f248dbb,0x3f1bd7ca,0x3f12d5e8,0x3f098c78,0x3eec6a50,0x3ed34e56,0x3eb9917b,0x3e9f4757,0x3e8483ee,0x3e47c5c2,0x3e05a8a8,0x3d85f213,0x3d32aa3e,0xbd060472,0xbddef599,0xbe3cce2b
.long 0xbe31d0d4,0xbe8483ee,0xbeaf1d44,0xbed8616c,0xbec3ef15,0xbef15aea,0xbf0e39da,0xbf226799,0xbf12d5e8,0xbf28cae3,0xbf3cbe35,0xbf4e7327,0xbf3cbe35,0xbf5016b8,0xbf60712a,0xbf6d9156
.long 0xbf5db3d7,0xbf6c835e,0xbf7746ea,0xbf7dcf55,0xbf7426cb,0xbf7c94a8,0xbf7ff067,0xbf7e28c6,0xbf7f069e,0xbf7f73af,0xbf79ee89,0xbf6e9811,0xbf7dcf55,0xbf74fa0b,0xbf659974,0xbf5016b8
.long 0x3f800000,0x3f800000,0x3f800000,0x3f800000,0x3f7c1c5c,0x3f7b9c62,0x3f7b14be,0x3f7a8575,0x3f708fb2,0x3f6e9811,0x3f6c835e,0x3f6a51da,0x3f5db3d7,0x3f596550,0x3f54db31,0x3f5016b8
.long 0x3f441b7d,0x3f3cbe35,0x3f3504f3,0x3f2cf37b,0x3f248dbb,0x3f199e45,0x3f0e39da,0x3f026926,0x3f000000,0x3ee273aa,0x3ec3ef15,0x3ea493b7,0x3eaf1d44,0x3e89e6f1,0x3e47c5c2,0x3df52731
.long 0x3e31d0d4,0x3db27eb6,0x248d3132,0xbdb27eb6,0x248d3132,0xbdc8bd36,0xbe47c5c2,0xbe94a031,0xbe31d0d4,0xbe8f45c0,0xbec3ef15,0xbef64429,0xbeaf1d44,0xbee77284,0xbf0e39da,0xbf26aed9
.long 0xbf000000,0xbf1bd7ca,0xbf3504f3,0xbf4b1934,0xbf248dbb,0xbf3e9e4b,0xbf54db31,0xbf66d223,0xbf441b7d,0xbf5adb81,0xbf6c835e,0xbf78a9e0,0xbf5db3d7,0xbf6f9788,0xbf7b14be,0xbf7fdce9
.long 0x3f800000,0x3f800000,0x3f800000,0x3f800000,0x3f79ee89,0x3f795000,0x3f78a9e0,0x3f77fc2c,0x3f6803ca,0x3f659974,0x3f631324,0x3f60712a,0x3f4b1934,0x3f45e403,0x3f407893,0x3f3ad85f
.long 0x3f248dbb,0x3f1bd7ca,0x3f12d5e8,0x3f098c78,0x3eec6a50,0x3ed34e56,0x3eb9917b,0x3e9f4757,0x3e8483ee,0x3e47c5c2,0x3e05a8a8,0x3d85f213,0x3d32aa3e,0xbd060472,0xbddef599,0xbe3cce2b
.long 0xbe31d0d4,0xbe8483ee,0xbeaf1d44,0xbed8616c,0xbec3ef15,0xbef15aea,0xbf0e39da,0xbf226799,0xbf12d5e8,0xbf28cae3,0xbf3cbe35,0xbf4e7327,0xbf3cbe35,0xbf5016b8,0xbf60712a,0xbf6d9156
.long 0xbf5db3d7,0xbf6c835e,0xbf7746ea,0xbf7dcf55,0xbf7426cb,0xbf7c94a8,0xbf7ff067,0xbf7e28c6,0xbf7f069e,0xbf7f73af,0xbf79ee89,0xbf6e9811,0xbf7dcf55,0xbf74fa0b,0xbf659974,0xbf5016b8
.long 0x80000000,0x80000000,0x80000000,0x80000000,0xbe31d0d4,0xbe3cce2b,0xbe47c5c2,0xbe52b743,0xbeaf1d44,0xbeb9917b,0xbec3ef15,0xbece34d0,0xbf000000,0xbf072f74,0xbf0e39da,0xbf151d42
.long 0xbf248dbb,0xbf2cf37b,0xbf3504f3,0xbf3cbe35,0xbf441b7d,0xbf4cc94c,0xbf54db31,0xbf5c4b07,0xbf5db3d7,0xbf659974,0xbf6c835e,0xbf726a03,0xbf708fb2,0xbf768a20,0xbf7b14be,0xbf7e28c6
.long 0xbf7c1c5c,0xbf7f069e,0xbf800000,0xbf7f069e,0xbf800000,0xbf7ec46d,0xbf7b14be,0xbf74fa0b,0xbf7c1c5c,0xbf75c5d4,0xbf6c835e,0xbf60712a,0xbf708fb2,0xbf6459c6,0xbf54db31,0xbf424cfe
.long 0xbf5db3d7,0xbf4b1934,0xbf3504f3,0xbf1bd7ca,0xbf441b7d,0xbf2ae1c9,0xbf0e39da,0xbedd6dea,0xbf248dbb,0xbf04ce53,0xbec3ef15,0xbe7363ee,0xbf000000,0xbeb45a1e,0xbe47c5c2,0xbd060472
.long 0x80000000,0x80000000,0x80000000,0x80000000,0xbe5da259,0xbe6886ae,0xbe7363ee,0xbe7e39c4,0xbed8616c,0xbee273aa,0xbeec6a50,0xbef64429,0xbf1bd7ca,0xbf226799,0xbf28cae3,0xbf2effe8
.long 0xbf441b7d,0xbf4b1934,0xbf51b3f3,0xbf57e880,0xbf631324,0xbf692e5f,0xbf6e9811,0xbf734c1c,0xbf7746ea,0xbf7b14be,0xbf7dcf55,0xbf7f73af,0xbf7fc1a0,0xbf7fdce9,0xbf7e7a7a,0xbf7b9c62
.long 0xbf7c1c5c,0xbf7746ea,0xbf708fb2,0xbf6803ca,0xbf6c835e,0xbf61c598,0xbf54db31,0xbf45e403,0xbf51b3f3,0xbf407893,0xbf2cf37b,0xbf176012,0xbf2cf37b,0xbf151d42,0xbef64429,0xbebec330
.long 0xbf000000,0xbec3ef15,0xbe8483ee,0xbe05a8a8,0xbe99f61c,0xbe26ce12,0xbcb2b521,0x3df52731,0xbdb27eb6,0x3d85f213,0x3e5da259,0x3eb9917b,0x3e05a8a8,0x3e94a031,0x3ee273aa,0x3f151d42
.long 0x80000000,0x80000000,0x80000000,0x80000000,0xbe31d0d4,0xbe3cce2b,0xbe47c5c2,0xbe52b743,0xbeaf1d44,0xbeb9917b,0xbec3ef15,0xbece34d0,0xbf000000,0xbf072f74,0xbf0e39da,0xbf151d42
.long 0xbf248dbb,0xbf2cf37b,0xbf3504f3,0xbf3cbe35,0xbf441b7d,0xbf4cc94c,0xbf54db31,0xbf5c4b07,0xbf5db3d7,0xbf659974,0xbf6c835e,0xbf726a03,0xbf708fb2,0xbf768a20,0xbf7b14be,0xbf7e28c6
.long 0xbf7c1c5c,0xbf7f069e,0xbf800000,0xbf7f069e,0xbf800000,0xbf7ec46d,0xbf7b14be,0xbf74fa0b,0xbf7c1c5c,0xbf75c5d4,0xbf6c835e,0xbf60712a,0xbf708fb2,0xbf6459c6,0xbf54db31,0xbf424cfe
.long 0xbf5db3d7,0xbf4b1934,0xbf3504f3,0xbf1bd7ca,0xbf441b7d,0xbf2ae1c9,0xbf0e39da,0xbedd6dea,0xbf248dbb,0xbf04ce53,0xbec3ef15,0xbe7363ee,0xbf000000,0xbeb45a1e,0xbe47c5c2,0xbd060472
.long 0x80000000,0x80000000,0x80000000,0x80000000,0xbe5da259,0xbe6886ae,0xbe7363ee,0xbe7e39c4,0xbed8616c,0xbee273aa,0xbeec6a50,0xbef64429,0xbf1bd7ca,0xbf226799,0xbf28cae3,0xbf2effe8
.long 0xbf441b7d,0xbf4b1934,0xbf51b3f3,0xbf57e880,0xbf631324,0xbf692e5f,0xbf6e9811,0xbf734c1c,0xbf7746ea,0xbf7b14be,0xbf7dcf55,0xbf7f73af,0xbf7fc1a0,0xbf7fdce9,0xbf7e7a7a,0xbf7b9c62
.long 0xbf7c1c5c,0xbf7746ea,0xbf708fb2,0xbf6803ca,0xbf6c835e,0xbf61c598,0xbf54db31,0xbf45e403,0xbf51b3f3,0xbf407893,0xbf2cf37b,0xbf176012,0xbf2cf37b,0xbf151d42,0xbef64429,0xbebec330
.long 0xbf000000,0xbec3ef15,0xbe8483ee,0xbe05a8a8,0xbe99f61c,0xbe26ce12,0xbcb2b521,0x3df52731,0xbdb27eb6,0x3d85f213,0x3e5da259,0x3eb9917b,0x3e05a8a8,0x3e94a031,0x3ee273aa,0x3f151d42
.long 0x3f80,0x3f80,0x3f80,0x3f80,0x3f80248d,0x3f80248d,0x3f80248d,0x3f80248d,0x3f80,0x3e853f77,0x3f003f5e,0x3f353f35,0x3f80248d,0x3f77be85,0x3f5ebf00,0x3f35bf35
.long 0x3f80,0x3f003f5e,0x3f5e3f00,0x3f80248d,0x3f80248d,0x3f5ebf00,0x3f00bf5e,0x250dbf80,0x3f80,0x3f353f35,0x3f80248d,0x3f35bf35,0x3f80248d,0x3f35bf35,0x250dbf80,0xbf35bf35
.long 0x3f80,0x3f5e3f00,0x3f5ebf00,0x250dbf80,0x3f80248d,0x3f00bf5e,0xbf00bf5e,0xbf80a554,0x3f80,0x3f773e85,0x3f00bf5e,0xbf35bf35,0x3f80248d,0x3e85bf77,0xbf5ebf00,0xbf353f35
.long 0x3f80,0x3f80248d,0x250dbf80,0xbf80a554,0x3f80248d,0x250dbf80,0xbf80a554,0xa58d3f80,0x3f80,0x3f77be85,0xbf00bf5e,0xbf353f35,0x3f80248d,0xbe85bf77,0xbf5e3f00,0x3f353f35
.long 0x3f80,0x3f80,0x3f80,0x3f80,0x3f80248d,0x3f80248d,0x3f80248d,0x3f80248d,0x3f5e3f00,0x3f773e85,0x3f80248d,0x3f77be85,0x3f00bf5e,0x3e85bf77,0x250dbf80,0xbe85bf77
.long 0x3f5ebf00,0x3f00bf5e,0x250dbf80,0xbf00bf5e,0xbf00bf5e,0xbf5ebf00,0xbf80a554,0xbf5e3f00,0x250dbf80,0xbf35bf35,0xbf80a554,0xbf353f35,0xbf80a554,0xbf353f35,0xa58d3f80,0x3f353f35
.long 0xbf5ebf00,0xbf5e3f00,0xa58d3f80,0x3f5e3f00,0xbf003f5e,0x3f003f5e,0x3f8025b0,0x3f00bf5e,0xbf5e3f00,0x3e853f77,0x3f8025b0,0x3e85bf77,0x3f003f5e,0x3f77be85,0x25d4bf80,0xbf77be85
.long 0xa58d3f80,0x3f8025b0,0x25d4bf80,0xbf80a5f7,0x3f8025b0,0x25d4bf80,0xbf80a5f7,0xa60d3f80,0x3f5e3f00,0x3e85bf77,0xbf80a5f7,0x3e853f77,0x3f00bf5e,0xbf77be85,0xa60d3f80,0x3f77be85
.long 0x3f80,0x3f80,0x3f80,0x3f80,0x3f80248d,0x3f80248d,0x3f80248d,0x3f80248d,0x3f5ebf00,0x3f35bf35,0x3f00bf5e,0x3e85bf77,0xbf00bf5e,0xbf35bf35,0xbf5ebf00,0xbf77be85
.long 0xbf5ebf00,0xbf80a554,0xbf5e3f00,0xbf003f5e,0xbf003f5e,0xa58d3f80,0x3f003f5e,0x3f5e3f00,0xa58d3f80,0x3f353f35,0x3f8025b0,0x3f35bf35,0x3f8025b0,0x3f35bf35,0x25d4bf80,0xbf35bf35
.long 0x3f5ebf00,0x25d4bf80,0xbf5ebf00,0xbf5e3f00,0xbf00bf5e,0xbf80a5f7,0xbf003f5e,0x3f003f5e,0xbf5ebf00,0xbf353f35,0x3f003f5e,0x3f77be85,0xbf003f5e,0x3f353f35,0x3f5ebf00,0xbe85bf77
.long 0xa60d3f80,0x3f80261f,0x2630bf80,0xbf80a731,0x3f80261f,0x2630bf80,0xbf80a731,0xa6543f80,0x3f5ebf00,0xbf35bf35,0xbf003f5e,0x3f773e85,0xbf00bf5e,0xbf353f35,0x3f5e3f00,0x3e85bf77
.long 0x3f80,0x3f80,0x3f80,0x3f80,0x3f80248d,0x3f80248d,0x3f80248d,0x3f80248d,0x250dbf80,0xbe85bf77,0xbf00bf5e,0xbf35bf35,0xbf80a554,0xbf773e85,0xbf5e3f00,0xbf353f35
.long 0xa58d3f80,0x3f003f5e,0x3f5e3f00,0x3f8025b0,0x3f8025b0,0x3f5ebf00,0x3f00bf5e,0x25d4bf80,0x25d4bf80,0xbf35bf35,0xbf80a5f7,0xbf353f35,0xbf80a5f7,0xbf353f35,0xa60d3f80,0x3f353f35
.long 0xa60d3f80,0x3f5e3f00,0x3f5ebf00,0x2630bf80,0x3f80261f,0x3f00bf5e,0xbf00bf5e,0xbf80a731,0x2630bf80,0xbf77be85,0xbf003f5e,0x3f353f35,0xbf80a731,0xbe853f77,0x3f5e3f00,0x3f35bf35
.long 0xa6543f80,0x3f80a68d,0x2677bf80,0xbf80a742,0x3f80a68d,0x2677bf80,0xbf80a742,0xa68d3f80,0x2677bf80,0xbf773e85,0x3f003f5e,0x3f35bf35,0xbf80a742,0x3e853f77,0x3f5ebf00,0xbf35bf35
.long 0x3f80,0x3f5ebf00,0xbf5ebf00,0xa58d3f80,0x3f80248d,0xbf00bf5e,0xbf003f5e,0x3f8025b0,0x3f80,0x3f35bf35,0xbf80a554,0x3f353f35,0x3f80248d,0xbf35bf35,0xa58d3f80,0x3f35bf35
.long 0x3f80,0x3f00bf5e,0xbf5e3f00,0x3f8025b0,0x3f80248d,0xbf5ebf00,0x3f003f5e,0x25d4bf80,0x3f80,0x3e85bf77,0xbf003f5e,0x3f35bf35,0x3f80248d,0xbf77be85,0x3f5e3f00,0xbf35bf35
.long 0x3f80,0x250dbf80,0xa58d3f80,0x25d4bf80,0xbf80248d,0x3f80248d,0xbf80a554,0x3f8025b0,0x3f80,0xbe85bf77,0x3f003f5e,0xbf35bf35,0xbf80248d,0x3f77be85,0xbf5e3f00,0x3f35bf35
.long 0x3f80,0xbf00bf5e,0x3f5e3f00,0xbf80a5f7,0xbf80248d,0x3f5ebf00,0xbf003f5e,0x25d4bf80,0x3f80,0xbf35bf35,0x3f8025b0,0xbf353f35,0xbf80248d,0x3f35bf35,0xa58d3f80,0xbf35bf35
.long 0x3f5ebf00,0xbf5ebf00,0xa60d3f80,0x3f5ebf00,0xbf00bf5e,0xbf003f5e,0x3f80261f,0xbf00bf5e,0x25d4bf80,0xbf353f35,0x3f80261f,0xbf35bf35,0xbf80a5f7,0x3f353f35,0x2630bf80,0xbf353f35
.long 0xbf5ebf00,0x3f003f5e,0x2630bf80,0xbf003f5e,0xbf003f5e,0x3f5ebf00,0xbf80a731,0x3f5e3f00,0xbf5e3f00,0x3f77be85,0xbf80a731,0x3f773e85,0x3f003f5e,0xbe85bf77,0xa6543f80,0x3e85bf77
.long 0xa60d3f80,0x2630bf80,0xa6543f80,0x2677bf80,0xbf80a5f7,0x3f80261f,0xbf80a731,0x3f80a68d,0x3f5e3f00,0xbf77be85,0x3f80a68d,0xbf773e85,0xbf003f5e,0x3e85bf77,0xa6543f80,0xbe85bf77
.long 0x3f5ebf00,0xbf003f5e,0x2677bf80,0x3f003f5e,0x3f003f5e,0xbf5ebf00,0x3f80a68d,0xbf5e3f00,0x2630bf80,0x3f353f35,0xbf80a742,0x3f35bf35,0x3f80261f,0xbf353f35,0x2677bf80,0x3f353f35
.long 0xbf5ebf00,0xa6543f80,0x3f5ebf00,0xbf5ebf00,0xbf003f5e,0x3f80a68d,0xbf00bf5e,0xbf003f5e,0xa6543f80,0x3f35bf35,0xbf80a742,0x3f353f35,0x3f80a68d,0xbf35bf35,0xa68d3f80,0x3f35bf35
.long 0x3f5ebf00,0xbf80a742,0x3f5e3f00,0xbf00bf5e,0xbf00bf5e,0xa68d3f80,0x3f00bf5e,0xbf5e3f00,0xbf5ebf00,0x3f353f35,0xbf00bf5e,0x3e853f77,0xbf003f5e,0x3f35bf35,0xbf5e3f00,0x3f77be85
.long 0xa68d3f80,0x269fbf80,0xa6b03f80,0x27b1bf80,0xbf80a742,0x3f80a654,0xbf80a754,0x3f80a60d,0x3f5ebf00,0xbf353f35,0x3f00bf5e,0xbe853f77,0x3f003f5e,0xbf35bf35,0x3f5e3f00,0xbf77be85
.long 0xbf5ebf00,0x3f80a60d,0xbf5e3f00,0x3f00bf5e,0x3f00bf5e,0xa6b03f80,0xbf00bf5e,0x3f5e3f00,0xa6b03f80,0xbf35bf35,0x3f80a58e,0xbf353f35,0xbf80a754,0x3f35bf35,0xa6d43f80,0xbf35bf35
.long 0xa68d3f80,0x3f5ebf00,0xbf5ebf00,0xa6b03f80,0x3f80a654,0xbf00bf5e,0xbf003f5e,0x3f80a60d,0x269fbf80,0xbf353f35,0x3f80a60d,0xbf35bf35,0xbf80a754,0x3f353f35,0x27b1bf80,0xbf353f35
.long 0xa6b03f80,0x3f00bf5e,0xbf5e3f00,0x3f80a58e,0x3f80a60d,0xbf5ebf00,0x3f003f5e,0xa70dbf80,0x27b1bf80,0xbe853f77,0x3f00bf5e,0xbf353f35,0xbf80a765,0x3f773e85,0xbf5ebf00,0x3f353f35
.long 0xa6d43f80,0xa70dbf80,0xa6f73f80,0x27c2bf80,0xbf80a765,0x3f80a58e,0xbf80a777,0x3f80a137,0xa70dbf80,0x3e853f77,0xbf00bf5e,0x3f353f35,0x3f80a58e,0xbf773e85,0x3f5ebf00,0xbf353f35
.long 0xa6f73f80,0xbf00bf5e,0x3f5e3f00,0xbf80a78d,0xbf80a777,0x3f5ebf00,0xbf003f5e,0xa6d4bf80,0x27c2bf80,0x3f353f35,0xbf80a78d,0x3f35bf35,0x3f80a137,0xbf353f35,0xa6d4bf80,0x3f353f35
.long 0x3f80,0xbf5ebf00,0x3f5ebf00,0xa60d3f80,0xbf80248d,0x3f00bf5e,0x3f003f5e,0xbf80a5f7,0x3f80,0xbf77be85,0x3f00bf5e,0x3f353f35,0xbf80248d,0x3e85bf77,0x3f5e3f00,0xbf353f35
.long 0x3f80,0xbf80a554,0x25d4bf80,0x3f80261f,0xbf80248d,0x250dbf80,0x3f8025b0,0xa60d3f80,0x3f80,0xbf773e85,0xbf00bf5e,0x3f35bf35,0xbf80248d,0xbe85bf77,0x3f5ebf00,0x3f353f35
.long 0x3f80,0xbf5e3f00,0xbf5ebf00,0x2630bf80,0xbf80248d,0xbf00bf5e,0x3f00bf5e,0x3f80261f,0x3f80,0xbf353f35,0xbf80a5f7,0xbf35bf35,0xbf80248d,0xbf35bf35,0x25d4bf80,0x3f35bf35
.long 0x3f80,0xbf003f5e,0xbf5e3f00,0xbf80a731,0xbf80248d,0xbf5ebf00,0xbf00bf5e,0x2630bf80,0x3f80,0xbe853f77,0xbf003f5e,0xbf353f35,0xbf80248d,0xbf77be85,0xbf5ebf00,0xbf35bf35
.long 0xbf5ebf00,0x3f5ebf00,0xa68d3f80,0xbf5ebf00,0x3f00bf5e,0x3f003f5e,0xbf80a742,0x3f00bf5e,0xbf5e3f00,0xbe85bf77,0x3f80a654,0xbe853f77,0xbf00bf5e,0x3f77be85,0xa68d3f80,0xbf77be85
.long 0xa6543f80,0xbf80a742,0x269fbf80,0x3f80a60d,0xbf80a731,0x2677bf80,0x3f80a654,0xa6b03f80,0x3f5e3f00,0xbe853f77,0xbf80a754,0xbe85bf77,0xbf003f5e,0xbf77be85,0x269fbf80,0x3f77be85
.long 0x3f5ebf00,0x3f5e3f00,0xa6b03f80,0xbf5e3f00,0x3f003f5e,0xbf003f5e,0xbf80a754,0xbf00bf5e,0x2677bf80,0x3f35bf35,0x3f80a60d,0x3f353f35,0x3f80a68d,0x3f353f35,0xa6b03f80,0xbf353f35
.long 0xbf5ebf00,0xbf00bf5e,0x27b1bf80,0x3f00bf5e,0x3f00bf5e,0x3f5ebf00,0x3f80a60d,0x3f5e3f00,0xbf5e3f00,0xbf773e85,0xbf80a765,0xbf77be85,0xbf00bf5e,0xbe85bf77,0x27b1bf80,0x3e85bf77
.long 0x3f5ebf00,0xa6d43f80,0xbf5ebf00,0x3f5ebf00,0x3f003f5e,0xbf80a765,0x3f00bf5e,0x3f003f5e,0xbf5ebf00,0x3f35bf35,0x3f003f5e,0xbf773e85,0x3f00bf5e,0x3f353f35,0xbf5e3f00,0xbe85bf77
.long 0xa6d43f80,0xbf80a777,0x27c2bf80,0x3f80258d,0xbf80a765,0xa70dbf80,0x3f80a137,0xa70d3f80,0x3f5ebf00,0x3f353f35,0xbf003f5e,0xbf77be85,0x3f003f5e,0xbf353f35,0xbf5ebf00,0x3e85bf77
.long 0xbf5ebf00,0x27c2bf80,0x3f5ebf00,0x3f5e3f00,0x3f00bf5e,0x3f80a137,0x3f003f5e,0xbf003f5e,0xa6f73f80,0xbf353f35,0xbf80a78d,0xbf35bf35,0xbf80a777,0xbf35bf35,0xa6d4bf80,0x3f35bf35
.long 0x3f5ebf00,0x3f80258d,0x3f5e3f00,0x3f003f5e,0x3f003f5e,0xa70d3f80,0xbf003f5e,0xbf5e3f00,0xbf5ebf00,0xbf35bf35,0xbf00bf5e,0xbe85bf77,0x3f00bf5e,0x3f35bf35,0x3f5ebf00,0x3f77be85
.long 0xa70d3f80,0xbf5ebf00,0x3f5ebf00,0xa7303f80,0xbf80a784,0x3f00bf5e,0x3f003f5e,0xbf80a796,0xa6d4bf80,0x3f773e85,0xbf003f5e,0xbf35bf35,0x3f80258d,0xbe853f77,0xbf5ebf00,0x3f35bf35
.long 0xa71f3f80,0xbf80a796,0xa68dbf80,0x3f80268d,0xbf80a78d,0x27d4bf80,0x3f80280d,0xa8313f80,0x27d4bf80,0x3f77be85,0x3f003f5e,0xbf353f35,0x3f80260d,0x3e853f77,0xbf5e3f00,0xbf35bf35
.long 0xa7303f80,0xbf5e3f00,0xbf5ebf00,0xa60ebf80,0xbf80a796,0xbf00bf5e,0x3f00bf5e,0x3f802816,0xa68dbf80,0x3f35bf35,0x3f802816,0x3f353f35,0x3f80280d,0x3f353f35,0xa7543f80,0xbf353f35
.long 0xa8313f80,0xbf003f5e,0xbf5e3f00,0xbf80270d,0xbf80a79f,0xbf5ebf00,0xbf00bf5e,0x27f7bf80,0x27e5bf80,0x3e85bf77,0x3f00bf5e,0x3f35bf35,0x3f80268d,0x3f773e85,0x3f5e3f00,0x3f353f35
.long 0x3f80,0x3f80,0x3f80,0x3f80,0x3f80248d,0x3f80248d,0x3f80248d,0x3f80248d,0xbf5ebf00,0xbf77be85,0xbf80a554,0xbf773e85,0xbf003f5e,0xbe853f77,0xa58d3f80,0x3e853f77
.long 0x3f5ebf00,0x3f00bf5e,0x25d4bf80,0xbf00bf5e,0xbf00bf5e,0xbf5ebf00,0xbf80a5f7,0xbf5e3f00,0xa60d3f80,0x3f353f35,0x3f80261f,0x3f35bf35,0x3f80261f,0x3f35bf35,0x2630bf80,0xbf35bf35
.long 0xbf5ebf00,0xbf5e3f00,0xa6543f80,0x3f5e3f00,0xbf003f5e,0x3f003f5e,0x3f80a68d,0x3f00bf5e,0x3f5ebf00,0xbe85bf77,0xbf80a742,0xbe853f77,0xbf00bf5e,0xbf773e85,0xa68d3f80,0x3f773e85
.long 0xa68d3f80,0x3f80a654,0x269fbf80,0xbf80a754,0x3f80a654,0x269fbf80,0xbf80a754,0xa6b03f80,0xbf5ebf00,0xbe853f77,0x3f80a60d,0xbe85bf77,0xbf003f5e,0x3f773e85,0x27b1bf80,0xbf773e85
.long 0x3f80,0x3f80,0x3f80,0x3f80,0x3f80248d,0x3f80248d,0x3f80248d,0x3f80248d,0xbf5e3f00,0xbf353f35,0xbf003f5e,0xbe853f77,0x3f003f5e,0x3f353f35,0x3f5e3f00,0x3f773e85
.long 0xbf5ebf00,0xbf80a5f7,0xbf5e3f00,0xbf003f5e,0xbf003f5e,0xa60d3f80,0x3f003f5e,0x3f5e3f00,0x2630bf80,0xbf35bf35,0xbf80a731,0xbf353f35,0xbf80a731,0xbf353f35,0xa6543f80,0x3f353f35
.long 0x3f5ebf00,0x2677bf80,0xbf5ebf00,0xbf5e3f00,0xbf00bf5e,0xbf80a742,0xbf003f5e,0x3f003f5e,0x3f5e3f00,0x3f35bf35,0xbf00bf5e,0xbf773e85,0x3f00bf5e,0xbf35bf35,0xbf5e3f00,0x3e853f77
.long 0xa6b03f80,0x3f80a60d,0x27b1bf80,0xbf80a765,0x3f80a60d,0x27b1bf80,0xbf80a765,0xa6d43f80,0xbf5e3f00,0x3f353f35,0x3f00bf5e,0xbf77be85,0x3f003f5e,0x3f35bf35,0xbf5ebf00,0xbe853f77
.long 0x0,0x0,0x0,0x0,0x0,0x0,0x0,0x0,0x80008000,0x80008000,0x80008000,0x80000000,0x80000000,0x80000000,0x80000000,0x0
.long 0x8000,0x8000,0x8000,0x80008000,0x80008000,0x80008000,0x80008000,0x80000000,0x80000000,0x0,0x0,0x8000,0x0,0x8000,0x8000,0x80008000
.long 0x80008000,0x80000000,0x80000000,0x0,0x80000000,0x0,0x8000,0x8000,0x8000,0x80008000,0x80008000,0x80000000,0x80008000,0x80000000,0x80000000,0x0
.long 0x80000000,0x8000,0x8000,0x80008000,0x8000,0x8000,0x80008000,0x80000000,0x80008000,0x80000000,0x8000,0x80008000,0x80000000,0x0,0x8000,0x80000000
.long 0x0,0x0,0x0,0x0,0x0,0x0,0x0,0x0,0x80000000,0x80000000,0x80000000,0x80000000,0x0,0x0,0x0,0x0
.long 0x80008000,0x80008000,0x80000000,0x80000000,0x80000000,0x80000000,0x0,0x0,0x8000,0x80008000,0x80008000,0x80000000,0x80008000,0x80000000,0x80000000,0x0
.long 0x8000,0x8000,0x80008000,0x80000000,0x80008000,0x80008000,0x80000000,0x0,0x0,0x8000,0x80008000,0x80000000,0x8000,0x80008000,0x80000000,0x0
.long 0x80000000,0x8000,0x8000,0x80008000,0x8000,0x8000,0x80008000,0x80000000,0x80000000,0x0,0x8000,0x80008000,0x0,0x8000,0x80008000,0x80000000
.long 0x3f5ebf00,0xbf5ebf00,0xa6d43f80,0x3f5ebf00,0xbf00bf5e,0xbf003f5e,0x3f80a58e,0xbf00bf5e,0xa6d43f80,0x3f35bf35,0xbf80a777,0x3f353f35,0x3f80a58e,0xbf35bf35,0xa6f73f80,0x3f35bf35
.long 0xbf5ebf00,0x3f003f5e,0x27c2bf80,0xbf003f5e,0xbf003f5e,0x3f5ebf00,0xbf80a784,0x3f5e3f00,0x3f5ebf00,0xbf773e85,0x3f80258d,0xbf77be85,0xbf00bf5e,0x3e853f77,0xa6d4bf80,0xbe853f77
.long 0xa70d3f80,0xa6d4bf80,0xa71f3f80,0x27d4bf80,0xbf80a784,0x3f80258d,0xbf80a78d,0x3f80260d,0xbf5ebf00,0x3f773e85,0xbf80a796,0x3f77be85,0x3f00bf5e,0xbe853f77,0x27d4bf80,0x3e853f77
.long 0x3f5ebf00,0xbf003f5e,0xa68dbf80,0x3f003f5e,0x3f003f5e,0xbf5ebf00,0x3f80280d,0xbf5e3f00,0xa7303f80,0xbf35bf35,0x3f80268d,0xbf353f35,0xbf80a796,0x3f35bf35,0xa8313f80,0xbf35bf35
.long 0xbf5ebf00,0xa6f73f80,0x3f5ebf00,0xbf5ebf00,0xbf003f5e,0x3f80a137,0xbf00bf5e,0xbf003f5e,0x27c2bf80,0xbf353f35,0x3f80258d,0xbf35bf35,0xbf80a784,0x3f353f35,0xa6d4bf80,0xbf353f35
.long 0x3f5ebf00,0xbf80a78d,0x3f5e3f00,0xbf00bf5e,0xbf00bf5e,0xa71f3f80,0x3f00bf5e,0xbf5e3f00,0x3f5e3f00,0xbf35bf35,0x3f003f5e,0xbe85bf77,0x3f00bf5e,0xbf353f35,0x3f5ebf00,0xbf773e85
.long 0xa7303f80,0xa68dbf80,0xa8313f80,0x27e5bf80,0xbf80a796,0x3f80280d,0xbf80a79f,0x3f80268d,0xbf5e3f00,0x3f35bf35,0xbf003f5e,0x3e85bf77,0xbf00bf5e,0x3f353f35,0xbf5ebf00,0x3f773e85
.long 0xbf5ebf00,0x3f802816,0xbf5e3f00,0x3f00bf5e,0x3f00bf5e,0xa7543f80,0xbf00bf5e,0x3f5e3f00,0xa60ebf80,0x3f353f35,0xbf80270d,0x3f35bf35,0x3f802816,0xbf353f35,0x27f7bf80,0x3f353f35
.long 0x8000,0x80008000,0x80000000,0x8000,0x80008000,0x80000000,0x8000,0x80008000,0x80000000,0x8000,0x80008000,0x0,0x8000,0x80008000,0x80000000,0x8000
.long 0x80008000,0x0,0x8000,0x80000000,0x80000000,0x8000,0x80008000,0x0,0x8000,0x80000000,0x0,0x80008000,0x80008000,0x0,0x80008000,0x80000000
.long 0x80000000,0x80008000,0x80000000,0x8000,0x80008000,0x0,0x80008000,0x0,0x80008000,0x0,0x80008000,0x8000,0x8000,0x80000000,0x8000,0x0
.long 0x8000,0x80000000,0x80008000,0x0,0x0,0x80008000,0x0,0x80000000,0x80000000,0x80008000,0x0,0x80000000,0x80008000,0x8000,0x80000000,0x80008000
.long 0x80008000,0x80000000,0x8000,0x80008000,0x80000000,0x8000,0x80008000,0x80000000,0x8000,0x80000000,0x0,0x80008000,0x80008000,0x0,0x80008000,0x80000000
.long 0x8000,0x80008000,0x0,0x80008000,0x80008000,0x80000000,0x8000,0x80000000,0x0,0x80008000,0x0,0x80008000,0x8000,0x80000000,0x8000,0x80000000
.long 0x80000000,0x80008000,0x80000000,0x8000,0x80008000,0x0,0x80008000,0x0,0x80000000,0x8000,0x80000000,0x8000,0x80008000,0x0,0x80008000,0x0
.long 0x80008000,0x0,0x80000000,0x8000,0x8000,0x80000000,0x80008000,0x0,0x80008000,0x0,0x80000000,0x8000,0x0,0x80000000,0x8000,0x0
.long 0xbf5ebf00,0x3f5ebf00,0xa7543f80,0xbf5ebf00,0x3f00bf5e,0x3f003f5e,0xbf802731,0x3f00bf5e,0x3f5ebf00,0x3e853f77,0xbf80a7b1,0x3e85bf77,0x3f003f5e,0xbf773e85,0xa60ebf80,0x3f773e85
.long 0xa7543f80,0xbf80a7b1,0x27f7bf80,0x3f80281f,0xbf802731,0xa60ebf80,0x3f8026d4,0xa7773f80,0xbf5ebf00,0x3e85bf77,0x3f80281f,0x3e853f77,0x3f00bf5e,0x3f773e85,0xa7773f80,0xbf773e85
.long 0x3f5ebf00,0x3f5e3f00,0xa8423f80,0xbf5e3f00,0x3f003f5e,0xbf003f5e,0xbf80a7c2,0xbf00bf5e,0xa7773f80,0xbf353f35,0xbf8026d4,0xbf35bf35,0xbf80270d,0xbf35bf35,0x2804bf80,0x3f35bf35
.long 0xbf5ebf00,0xbf00bf5e,0x260dbf80,0x3f00bf5e,0x3f00bf5e,0x3f5ebf00,0x3f802828,0x3f5e3f00,0x3f5ebf00,0x3f77be85,0x3f802730,0x3f773e85,0x3f003f5e,0x3e853f77,0x27543f80,0xbe853f77
.long 0x3f5ebf00,0xa7773f80,0xbf5ebf00,0x3f5ebf00,0x3f003f5e,0xbf80270d,0x3f00bf5e,0x3f003f5e,0x3f5e3f00,0xbf353f35,0xbf00bf5e,0x3f77be85,0xbf003f5e,0xbf35bf35,0x3f5ebf00,0x3e853f77
.long 0xa8423f80,0xbf8026d4,0x260dbf80,0x3f802730,0xbf80a7c2,0x2804bf80,0x3f802828,0x27543f80,0xbf5e3f00,0xbf35bf35,0x3f00bf5e,0x3f773e85,0xbf00bf5e,0x3f35bf35,0x3f5e3f00,0xbe853f77
.long 0xbf5ebf00,0x280dbf80,0x3f5ebf00,0x3f5e3f00,0x3f00bf5e,0x3f802730,0x3f003f5e,0xbf003f5e,0x280dbf80,0x3f35bf35,0x3f802754,0x3f353f35,0x3f802730,0x3f353f35,0xa8543f80,0xbf353f35
.long 0x3f5ebf00,0x3f802754,0x3f5e3f00,0x3f003f5e,0x3f003f5e,0xa8543f80,0xbf003f5e,0xbf5e3f00,0x3f5e3f00,0x3f353f35,0x3f003f5e,0x3e853f77,0xbf003f5e,0xbf353f35,0xbf5e3f00,0xbf773e85
.long 0x80008000,0x8000,0x80000000,0x80008000,0x8000,0x0,0x80000000,0x8000,0x8000,0x0,0x80008000,0x8000,0x0,0x80000000,0x80008000,0x0
.long 0x80000000,0x80008000,0x8000,0x0,0x80000000,0x80008000,0x0,0x80000000,0x80008000,0x8000,0x0,0x0,0x8000,0x0,0x80000000,0x80000000
.long 0x8000,0x0,0x80000000,0x80000000,0x0,0x80000000,0x80008000,0x80008000,0x80000000,0x80000000,0x80000000,0x80008000,0x80000000,0x80008000,0x8000,0x8000
.long 0x80008000,0x80008000,0x8000,0x8000,0x8000,0x8000,0x0,0x0,0x8000,0x8000,0x0,0x0,0x0,0x0,0x0,0x80000000
.long 0x8000,0x80000000,0x80008000,0x8000,0x0,0x80000000,0x8000,0x0,0x0,0x80000000,0x80008000,0x8000,0x80000000,0x80008000,0x8000,0x0
.long 0x80000000,0x80000000,0x8000,0x0,0x80008000,0x8000,0x0,0x0,0x80000000,0x80008000,0x8000,0x0,0x80008000,0x8000,0x0,0x80000000
.long 0x80008000,0x8000,0x8000,0x0,0x8000,0x0,0x0,0x80000000,0x8000,0x8000,0x0,0x0,0x0,0x0,0x80000000,0x80000000
.long 0x8000,0x0,0x0,0x0,0x0,0x80000000,0x80000000,0x80000000,0x0,0x0,0x0,0x0,0x80000000,0x80000000,0x80000000,0x80000000
.long 0x0,0x0,0x0,0x0,0x0,0x0,0x0,0x0,0x80008000,0x80008000,0x80008000,0x80000000,0x80000000,0x80000000,0x80000000,0x0
.long 0x8000,0x8000,0x8000,0x80008000,0x80008000,0x80008000,0x80008000,0x80000000,0x80000000,0x0,0x0,0x8000,0x0,0x8000,0x8000,0x80008000
.long 0x80008000,0x80000000,0x80000000,0x0,0x80000000,0x0,0x8000,0x8000,0x8000,0x80008000,0x80008000,0x80000000,0x80008000,0x80000000,0x80000000,0x0
.long 0x80000000,0x8000,0x8000,0x80008000,0x8000,0x8000,0x80008000,0x80000000,0x80008000,0x80000000,0x8000,0x80008000,0x80000000,0x0,0x8000,0x80000000
.long 0x0,0x0,0x0,0x0,0x0,0x0,0x0,0x0,0x80000000,0x80000000,0x80000000,0x80000000,0x0,0x0,0x0,0x0
.long 0x80008000,0x80008000,0x80000000,0x80000000,0x80000000,0x80000000,0x0,0x0,0x8000,0x80008000,0x80008000,0x80000000,0x80008000,0x80000000,0x80000000,0x0
.long 0x8000,0x8000,0x80008000,0x80000000,0x80008000,0x80008000,0x80000000,0x0,0x0,0x8000,0x80008000,0x80000000,0x8000,0x80008000,0x80000000,0x0
.long 0x80000000,0x8000,0x8000,0x80008000,0x8000,0x8000,0x80008000,0x80000000,0x80000000,0x0,0x8000,0x80008000,0x0,0x8000,0x80008000,0x80000000
.long 0x3f80,0x3f80,0x3f80,0x3f80,0x3f80248d,0x3f80248d,0x3f80248d,0x3f80248d,0xbf5ebf00,0xbf77be85,0xbf80a554,0xbf773e85,0xbf003f5e,0xbe853f77,0xa58d3f80,0x3e853f77
.long 0x3f5ebf00,0x3f00bf5e,0x25d4bf80,0xbf00bf5e,0xbf00bf5e,0xbf5ebf00,0xbf80a5f7,0xbf5e3f00,0xa60d3f80,0x3f353f35,0x3f80261f,0x3f35bf35,0x3f80261f,0x3f35bf35,0x2630bf80,0xbf35bf35
.long 0xbf5ebf00,0xbf5e3f00,0xa6543f80,0x3f5e3f00,0xbf003f5e,0x3f003f5e,0x3f80a68d,0x3f00bf5e,0x3f5ebf00,0xbe85bf77,0xbf80a742,0xbe853f77,0xbf00bf5e,0xbf773e85,0xa68d3f80,0x3f773e85
.long 0xa68d3f80,0x3f80a654,0x269fbf80,0xbf80a754,0x3f80a654,0x269fbf80,0xbf80a754,0xa6b03f80,0xbf5ebf00,0xbe853f77,0x3f80a60d,0xbe85bf77,0xbf003f5e,0x3f773e85,0x27b1bf80,0xbf773e85
.long 0x3f80,0x3f80,0x3f80,0x3f80,0x3f80248d,0x3f80248d,0x3f80248d,0x3f80248d,0xbf5e3f00,0xbf353f35,0xbf003f5e,0xbe853f77,0x3f003f5e,0x3f353f35,0x3f5e3f00,0x3f773e85
.long 0xbf5ebf00,0xbf80a5f7,0xbf5e3f00,0xbf003f5e,0xbf003f5e,0xa60d3f80,0x3f003f5e,0x3f5e3f00,0x2630bf80,0xbf35bf35,0xbf80a731,0xbf353f35,0xbf80a731,0xbf353f35,0xa6543f80,0x3f353f35
.long 0x3f5ebf00,0x2677bf80,0xbf5ebf00,0xbf5e3f00,0xbf00bf5e,0xbf80a742,0xbf003f5e,0x3f003f5e,0x3f5e3f00,0x3f35bf35,0xbf00bf5e,0xbf773e85,0x3f00bf5e,0xbf35bf35,0xbf5e3f00,0x3e853f77
.long 0xa6b03f80,0x3f80a60d,0x27b1bf80,0xbf80a765,0x3f80a60d,0x27b1bf80,0xbf80a765,0xa6d43f80,0xbf5e3f00,0x3f353f35,0x3f00bf5e,0xbf77be85,0x3f003f5e,0x3f35bf35,0xbf5ebf00,0xbe853f77
.long 0x8000,0x80008000,0x80000000,0x8000,0x80008000,0x80000000,0x8000,0x80008000,0x80000000,0x8000,0x80008000,0x0,0x8000,0x80008000,0x80000000,0x8000
.long 0x80008000,0x0,0x8000,0x80000000,0x80000000,0x8000,0x80008000,0x0,0x8000,0x80000000,0x0,0x80008000,0x80008000,0x0,0x80008000,0x80000000
.long 0x80000000,0x80008000,0x80000000,0x8000,0x80008000,0x0,0x80008000,0x0,0x80008000,0x0,0x80008000,0x8000,0x8000,0x80000000,0x8000,0x0
.long 0x8000,0x80000000,0x80008000,0x0,0x0,0x80008000,0x0,0x80000000,0x80000000,0x80008000,0x0,0x80000000,0x80008000,0x8000,0x80000000,0x80008000
.long 0x80008000,0x80000000,0x8000,0x80008000,0x80000000,0x8000,0x80008000,0x80000000,0x8000,0x80000000,0x0,0x80008000,0x80008000,0x0,0x80008000,0x80000000
.long 0x8000,0x80008000,0x0,0x80008000,0x80008000,0x80000000,0x8000,0x80000000,0x0,0x80008000,0x0,0x80008000,0x8000,0x80000000,0x8000,0x80000000
.long 0x80000000,0x80008000,0x80000000,0x8000,0x80008000,0x0,0x80008000,0x0,0x80000000,0x8000,0x80000000,0x8000,0x80008000,0x0,0x80008000,0x0
.long 0x80008000,0x0,0x80000000,0x8000,0x8000,0x80000000,0x80008000,0x0,0x80008000,0x0,0x80000000,0x8000,0x0,0x80000000,0x8000,0x0
.long 0x3f5ebf00,0xbf5ebf00,0xa6d43f80,0x3f5ebf00,0xbf00bf5e,0xbf003f5e,0x3f80a58e,0xbf00bf5e,0xa6d43f80,0x3f35bf35,0xbf80a777,0x3f353f35,0x3f80a58e,0xbf35bf35,0xa6f73f80,0x3f35bf35
.long 0xbf5ebf00,0x3f003f5e,0x27c2bf80,0xbf003f5e,0xbf003f5e,0x3f5ebf00,0xbf80a784,0x3f5e3f00,0x3f5ebf00,0xbf773e85,0x3f80258d,0xbf77be85,0xbf00bf5e,0x3e853f77,0xa6d4bf80,0xbe853f77
.long 0xa70d3f80,0xa6d4bf80,0xa71f3f80,0x27d4bf80,0xbf80a784,0x3f80258d,0xbf80a78d,0x3f80260d,0xbf5ebf00,0x3f773e85,0xbf80a796,0x3f77be85,0x3f00bf5e,0xbe853f77,0x27d4bf80,0x3e853f77
.long 0x3f5ebf00,0xbf003f5e,0xa68dbf80,0x3f003f5e,0x3f003f5e,0xbf5ebf00,0x3f80280d,0xbf5e3f00,0xa7303f80,0xbf35bf35,0x3f80268d,0xbf353f35,0xbf80a796,0x3f35bf35,0xa8313f80,0xbf35bf35
.long 0xbf5ebf00,0xa6f73f80,0x3f5ebf00,0xbf5ebf00,0xbf003f5e,0x3f80a137,0xbf00bf5e,0xbf003f5e,0x27c2bf80,0xbf353f35,0x3f80258d,0xbf35bf35,0xbf80a784,0x3f353f35,0xa6d4bf80,0xbf353f35
.long 0x3f5ebf00,0xbf80a78d,0x3f5e3f00,0xbf00bf5e,0xbf00bf5e,0xa71f3f80,0x3f00bf5e,0xbf5e3f00,0x3f5e3f00,0xbf35bf35,0x3f003f5e,0xbe85bf77,0x3f00bf5e,0xbf353f35,0x3f5ebf00,0xbf773e85
.long 0xa7303f80,0xa68dbf80,0xa8313f80,0x27e5bf80,0xbf80a796,0x3f80280d,0xbf80a79f,0x3f80268d,0xbf5e3f00,0x3f35bf35,0xbf003f5e,0x3e85bf77,0xbf00bf5e,0x3f353f35,0xbf5ebf00,0x3f773e85
.long 0xbf5ebf00,0x3f802816,0xbf5e3f00,0x3f00bf5e,0x3f00bf5e,0xa7543f80,0xbf00bf5e,0x3f5e3f00,0xa60ebf80,0x3f353f35,0xbf80270d,0x3f35bf35,0x3f802816,0xbf353f35,0x27f7bf80,0x3f353f35
.long 0x80008000,0x8000,0x80000000,0x80008000,0x8000,0x0,0x80000000,0x8000,0x8000,0x0,0x80008000,0x8000,0x0,0x80000000,0x80008000,0x0
.long 0x80000000,0x80008000,0x8000,0x0,0x80000000,0x80008000,0x0,0x80000000,0x80008000,0x8000,0x0,0x0,0x8000,0x0,0x80000000,0x80000000
.long 0x8000,0x0,0x80000000,0x80000000,0x0,0x80000000,0x80008000,0x80008000,0x80000000,0x80000000,0x80000000,0x80008000,0x80000000,0x80008000,0x8000,0x8000
.long 0x80008000,0x80008000,0x8000,0x8000,0x8000,0x8000,0x0,0x0,0x8000,0x8000,0x0,0x0,0x0,0x0,0x0,0x80000000
.long 0x8000,0x80000000,0x80008000,0x8000,0x0,0x80000000,0x8000,0x0,0x0,0x80000000,0x80008000,0x8000,0x80000000,0x80008000,0x8000,0x0
.long 0x80000000,0x80000000,0x8000,0x0,0x80008000,0x8000,0x0,0x0,0x80000000,0x80008000,0x8000,0x0,0x80008000,0x8000,0x0,0x80000000
.long 0x80008000,0x8000,0x8000,0x0,0x8000,0x0,0x0,0x80000000,0x8000,0x8000,0x0,0x0,0x0,0x0,0x80000000,0x80000000
.long 0x8000,0x0,0x0,0x0,0x0,0x80000000,0x80000000,0x80000000,0x0,0x0,0x0,0x0,0x80000000,0x80000000,0x80000000,0x80000000
.long 0xbf5ebf00,0x3f5ebf00,0xa7543f80,0xbf5ebf00,0x3f00bf5e,0x3f003f5e,0xbf802731,0x3f00bf5e,0x3f5ebf00,0x3e853f77,0xbf80a7b1,0x3e85bf77,0x3f003f5e,0xbf773e85,0xa60ebf80,0x3f773e85
.long 0xa7543f80,0xbf80a7b1,0x27f7bf80,0x3f80281f,0xbf802731,0xa60ebf80,0x3f8026d4,0xa7773f80,0xbf5ebf00,0x3e85bf77,0x3f80281f,0x3e853f77,0x3f00bf5e,0x3f773e85,0xa7773f80,0xbf773e85
.long 0x3f5ebf00,0x3f5e3f00,0xa8423f80,0xbf5e3f00,0x3f003f5e,0xbf003f5e,0xbf80a7c2,0xbf00bf5e,0xa7773f80,0xbf353f35,0xbf8026d4,0xbf35bf35,0xbf80270d,0xbf35bf35,0x2804bf80,0x3f35bf35
.long 0xbf5ebf00,0xbf00bf5e,0x260dbf80,0x3f00bf5e,0x3f00bf5e,0x3f5ebf00,0x3f802828,0x3f5e3f00,0x3f5ebf00,0x3f77be85,0x3f802730,0x3f773e85,0x3f003f5e,0x3e853f77,0x27543f80,0xbe853f77
.long 0x3f5ebf00,0xa7773f80,0xbf5ebf00,0x3f5ebf00,0x3f003f5e,0xbf80270d,0x3f00bf5e,0x3f003f5e,0x3f5e3f00,0xbf353f35,0xbf00bf5e,0x3f77be85,0xbf003f5e,0xbf35bf35,0x3f5ebf00,0x3e853f77
.long 0xa8423f80,0xbf8026d4,0x260dbf80,0x3f802730,0xbf80a7c2,0x2804bf80,0x3f802828,0x27543f80,0xbf5e3f00,0xbf35bf35,0x3f00bf5e,0x3f773e85,0xbf00bf5e,0x3f35bf35,0x3f5e3f00,0xbe853f77
.long 0xbf5ebf00,0x280dbf80,0x3f5ebf00,0x3f5e3f00,0x3f00bf5e,0x3f802730,0x3f003f5e,0xbf003f5e,0x280dbf80,0x3f35bf35,0x3f802754,0x3f353f35,0x3f802730,0x3f353f35,0xa8543f80,0xbf353f35
.long 0x3f5ebf00,0x3f802754,0x3f5e3f00,0x3f003f5e,0x3f003f5e,0xa8543f80,0xbf003f5e,0xbf5e3f00,0x3f5e3f00,0x3f353f35,0x3f003f5e,0x3e853f77,0xbf003f5e,0xbf353f35,0xbf5e3f00,0xbf773e85
.long 0x0,0x300,0x20,0x320,0x8,0x308,0x28,0x328,0x10,0x310,0x4a0,0x7a0,0x18,0x318,0x4a8,0x7a8
.long 0x30,0x330,0x50,0x350,0x38,0x338,0x58,0x358,0x40,0x340,0x4d0,0x7d0,0x48,0x348,0x4d8,0x7d8
.long 0x60,0x360,0x80,0x380,0x68,0x368,0x88,0x388,0x70,0x370,0x500,0x800,0x78,0x378,0x508,0x808
.long 0x90,0x390,0xb0,0x3b0,0x98,0x398,0xb8,0x3b8,0xa0,0x3a0,0x530,0x830,0xa8,0x3a8,0x538,0x838
.long 0xc0,0x3c0,0xe0,0x3e0,0xc8,0x3c8,0xe8,0x3e8,0xd0,0x3d0,0x560,0x860,0xd8,0x3d8,0x568,0x868
.long 0xf0,0x3f0,0x110,0x410,0xf8,0x3f8,0x118,0x418,0x100,0x400,0x590,0x890,0x108,0x408,0x598,0x898
.long 0x120,0x420,0x140,0x440,0x128,0x428,0x148,0x448,0x130,0x430,0x5c0,0x8c0,0x138,0x438,0x5c8,0x8c8
.long 0x150,0x450,0x170,0x470,0x158,0x458,0x178,0x478,0x160,0x460,0x5f0,0x8f0,0x168,0x468,0x5f8,0x8f8
.long 0x180,0x300,0x1a0,0x320,0x188,0x308,0x1a8,0x328,0x190,0x310,0x620,0x7a0,0x198,0x318,0x628,0x7a8
.long 0x1b0,0x330,0x1d0,0x350,0x1b8,0x338,0x1d8,0x358,0x1c0,0x340,0x650,0x7d0,0x1c8,0x348,0x658,0x7d8
.long 0x1e0,0x360,0x200,0x380,0x1e8,0x368,0x208,0x388,0x1f0,0x370,0x680,0x800,0x1f8,0x378,0x688,0x808
.long 0x210,0x390,0x230,0x3b0,0x218,0x398,0x238,0x3b8,0x220,0x3a0,0x6b0,0x830,0x228,0x3a8,0x6b8,0x838
.long 0x240,0x3c0,0x260,0x3e0,0x248,0x3c8,0x268,0x3e8,0x250,0x3d0,0x6e0,0x860,0x258,0x3d8,0x6e8,0x868
.long 0x270,0x3f0,0x290,0x410,0x278,0x3f8,0x298,0x418,0x280,0x400,0x710,0x890,0x288,0x408,0x718,0x898
.long 0x2a0,0x420,0x2c0,0x440,0x2a8,0x428,0x2c8,0x448,0x2b0,0x430,0x740,0x8c0,0x2b8,0x438,0x748,0x8c8
.long 0x2d0,0x450,0x2f0,0x470,0x2d8,0x458,0x2f8,0x478,0x2e0,0x460,0x770,0x8f0,0x2e8,0x468,0x778,0x8f8
.long 0x0,0x620,0x3000,0x3620,0x40,0x660,0x3040,0x3660,0x80,0x6a0,0x3080,0x36a0,0xc0,0x6e0,0x30c0,0x36e0
.long 0x110,0x730,0x3110,0x3730,0x150,0x770,0x3150,0x3770,0x190,0x7b0,0x3190,0x37b0,0x1d0,0x7f0,0x31d0,0x37f0
.long 0x220,0x800,0x3220,0x3800,0x260,0x840,0x3260,0x3840,0x2a0,0x880,0x32a0,0x3880,0x2e0,0x8c0,0x32e0,0x38c0
.long 0x330,0x910,0x3330,0x3910,0x330,0x910,0x3330,0x3910,0x330,0x910,0x3330,0x3910,0x330,0x910,0x3330,0x3910
.long 0xc00,0x1220,0x3c00,0x4220,0xc40,0x1260,0x3c40,0x4260,0xc80,0x12a0,0x3c80,0x42a0,0xcc0,0x12e0,0x3cc0,0x42e0
.long 0xd10,0x1330,0x3d10,0x4330,0xd50,0x1370,0x3d50,0x4370,0xd90,0x13b0,0x3d90,0x43b0,0xdd0,0x13f0,0x3dd0,0x43f0
.long 0xe20,0x1400,0x3e20,0x4400,0xe60,0x1440,0x3e60,0x4440,0xea0,0x1480,0x3ea0,0x4480,0xee0,0x14c0,0x3ee0,0x44c0
.long 0xf30,0x1510,0x3f30,0x4510,0xf30,0x1510,0x3f30,0x4510,0xf30,0x1510,0x3f30,0x4510,0xf30,0x1510,0x3f30,0x4510
.long 0x1800,0x1e20,0x4800,0x4220,0x1840,0x1e60,0x47f0,0x41d0,0x1880,0x1ea0,0x47b0,0x4190,0x18c0,0x1ee0,0x4770,0x4150
.long 0x1910,0x1f30,0x4730,0x4110,0x1950,0x1f70,0x46e0,0x40c0,0x1990,0x1fb0,0x46a0,0x4080,0x19d0,0x1ff0,0x4660,0x4040
.long 0x1a20,0x2000,0x4620,0x4000,0x1a60,0x2040,0x45d0,0x3ff0,0x1aa0,0x2080,0x4590,0x3fb0,0x1ae0,0x20c0,0x4550,0x3f70
.long 0x1b30,0x2110,0x4510,0x3f30,0x1b30,0x2110,0x4510,0x3f30,0x1b30,0x2110,0x4510,0x3f30,0x1b30,0x2110,0x4510,0x3f30
.long 0x2400,0x2a20,0x3c00,0x3620,0x2440,0x2a60,0x3bf0,0x35d0,0x2480,0x2aa0,0x3bb0,0x3590,0x24c0,0x2ae0,0x3b70,0x3550
.long 0x2510,0x2b30,0x3b30,0x3510,0x2550,0x2b70,0x3ae0,0x34c0,0x2590,0x2bb0,0x3aa0,0x3480,0x25d0,0x2bf0,0x3a60,0x3440
.long 0x2620,0x2c00,0x3a20,0x3400,0x2660,0x2c40,0x39d0,0x33f0,0x26a0,0x2c80,0x3990,0x33b0,0x26e0,0x2cc0,0x3950,0x3370
.long 0x2730,0x2d10,0x3910,0x3330,0x2730,0x2d10,0x3910,0x3330,0x2730,0x2d10,0x3910,0x3330,0x2730,0x2d10,0x3910,0x3330
.long 0x3000,0x2a20,0x0,0x0,0x2ff0,0x29d0,0x0,0x0,0x2fb0,0x2990,0x0,0x0,0x2f70,0x2950,0x0,0x0
.long 0x2f30,0x2910,0x0,0x0,0x2ee0,0x28c0,0x0,0x0,0x2ea0,0x2880,0x0,0x0,0x2e60,0x2840,0x0,0x0
.long 0x2e20,0x2800,0x0,0x0,0x2dd0,0x27f0,0x0,0x0,0x2d90,0x27b0,0x0,0x0,0x2d50,0x2770,0x0,0x0
.long 0x2d10,0x2730,0x0,0x0,0x2d10,0x2730,0x0,0x0,0x2d10,0x2730,0x0,0x0,0x2d10,0x2730,0x0,0x0
.long 0x2400,0x1e20,0x0,0x0,0x23f0,0x1dd0,0x0,0x0,0x23b0,0x1d90,0x0,0x0,0x2370,0x1d50,0x0,0x0
.long 0x2330,0x1d10,0x0,0x0,0x22e0,0x1cc0,0x0,0x0,0x22a0,0x1c80,0x0,0x0,0x2260,0x1c40,0x0,0x0
.long 0x2220,0x1c00,0x0,0x0,0x21d0,0x1bf0,0x0,0x0,0x2190,0x1bb0,0x0,0x0,0x2150,0x1b70,0x0,0x0
.long 0x2110,0x1b30,0x0,0x0,0x2110,0x1b30,0x0,0x0,0x2110,0x1b30,0x0,0x0,0x2110,0x1b30,0x0,0x0
.long 0x1800,0x1220,0x0,0x0,0x17f0,0x11d0,0x0,0x0,0x17b0,0x1190,0x0,0x0,0x1770,0x1150,0x0,0x0
.long 0x1730,0x1110,0x0,0x0,0x16e0,0x10c0,0x0,0x0,0x16a0,0x1080,0x0,0x0,0x1660,0x1040,0x0,0x0
.long 0x1620,0x1000,0x0,0x0,0x15d0,0xff0,0x0,0x0,0x1590,0xfb0,0x0,0x0,0x1550,0xf70,0x0,0x0
.long 0x1510,0xf30,0x0,0x0,0x1510,0xf30,0x0,0x0,0x1510,0xf30,0x0,0x0,0x1510,0xf30,0x0,0x0
.long 0xc00,0x620,0x0,0x0,0xbf0,0x5d0,0x0,0x0,0xbb0,0x590,0x0,0x0,0xb70,0x550,0x0,0x0
.long 0xb30,0x510,0x0,0x0,0xae0,0x4c0,0x0,0x0,0xaa0,0x480,0x0,0x0,0xa60,0x440,0x0,0x0
.long 0xa20,0x400,0x0,0x0,0x9d0,0x3f0,0x0,0x0,0x990,0x3b0,0x0,0x0,0x950,0x370,0x0,0x0
.long 0x910,0x330,0x0,0x0,0x910,0x330,0x0,0x0,0x910,0x330,0x0,0x0,0x910,0x330,0x0,0x0
.long 0x80003f80,0x80003f80,0x80003f80,0x80003f80,0x80003f80,0xbe853f77,0xbf003f5e,0xbf353f35,0x80003f80,0xbf003f5e,0xbf5e3f00,0xbf80248d,0x80003f80,0xbf353f35,0xbf80248d,0xbf35bf35
.long 0x80003f80,0xbf5e3f00,0xbf5ebf00,0xa50dbf80,0x80003f80,0xbf773e85,0xbf00bf5e,0x3f35bf35,0x80003f80,0xbf80248d,0xa50dbf80,0x3f80a554,0x80003f80,0xbf77be85,0x3f00bf5e,0x3f353f35
.long 0x80003f80,0xbf5ebf00,0x3f5ebf00,0x258d3f80,0x80003f80,0xbf35bf35,0x3f80a554,0xbf353f35,0x80003f80,0xbf00bf5e,0x3f5e3f00,0xbf8025b0,0x80003f80,0xbe85bf77,0x3f003f5e,0xbf35bf35
.long 0x80003f80,0xa50dbf80,0x258d3f80,0xa5d4bf80,0x80003f80,0x3e85bf77,0xbf003f5e,0x3f35bf35,0x80003f80,0x3f00bf5e,0xbf5e3f00,0x3f80a5f7,0x80003f80,0x3f35bf35,0xbf8025b0,0x3f353f35
.long 0x80003f80,0x80003f80,0x80003f80,0x80003f80,0xbf80248d,0xbf77be85,0xbf5ebf00,0xbf35bf35,0xa50dbf80,0x3f00bf5e,0x3f5ebf00,0x3f80a554,0x3f80a554,0x3f353f35,0x258d3f80,0xbf353f35
.long 0x258d3f80,0xbf5e3f00,0xbf5ebf00,0xa5d4bf80,0xbf8025b0,0xbe85bf77,0x3f5ebf00,0x3f353f35,0xa5d4bf80,0x3f80a5f7,0x260d3f80,0xbf80261f,0x3f80a5f7,0xbe853f77,0xbf5ebf00,0x3f35bf35
.long 0x260d3f80,0xbf5ebf00,0x3f5ebf00,0x26543f80,0xbf80261f,0x3f35bf35,0x26543f80,0xbf35bf35,0xa630bf80,0x3f003f5e,0xbf5ebf00,0x3f80a742,0x3f80a731,0xbf773e85,0x3f5ebf00,0xbf353f35
.long 0x26543f80,0xa677bf80,0x268d3f80,0xa69fbf80,0xbf80a68d,0x3f773e85,0xbf5ebf00,0x3f353f35,0xa677bf80,0xbf003f5e,0x3f5ebf00,0xbf80a60d,0x3f80a742,0xbf35bf35,0x26b03f80,0x3f35bf35
.long 0x3f80,0x3f80,0x3f80,0x3f80,0x250dbf80,0xbe85bf77,0xbf00bf5e,0xbf35bf35,0xa58d3f80,0x3f003f5e,0x3f5e3f00,0x3f8025b0,0x25d4bf80,0xbf35bf35,0xbf80a5f7,0xbf353f35
.long 0xa60d3f80,0x3f5e3f00,0x3f5ebf00,0x2630bf80,0x2630bf80,0xbf77be85,0xbf003f5e,0x3f353f35,0xa6543f80,0x3f80a68d,0x2677bf80,0xbf80a742,0x2677bf80,0xbf773e85,0x3f003f5e,0x3f35bf35
.long 0xa68d3f80,0x3f5ebf00,0xbf5ebf00,0xa6b03f80,0x269fbf80,0xbf353f35,0x3f80a60d,0xbf35bf35,0xa6b03f80,0x3f00bf5e,0xbf5e3f00,0x3f80a58e,0x27b1bf80,0xbe853f77,0x3f00bf5e,0xbf353f35
.long 0xa6d43f80,0xa70dbf80,0xa6f73f80,0x27c2bf80,0xa70dbf80,0x3e853f77,0xbf00bf5e,0x3f353f35,0xa6f73f80,0xbf00bf5e,0x3f5e3f00,0xbf80a78d,0x27c2bf80,0x3f353f35,0xbf80a78d,0x3f35bf35
.long 0x3f80,0x3f80,0x3f80,0x3f80,0xbf80a554,0xbf773e85,0xbf5e3f00,0xbf353f35,0x25d4bf80,0xbf00bf5e,0xbf5ebf00,0xbf80a5f7,0x3f80261f,0x3f35bf35,0x2630bf80,0xbf35bf35
.long 0xa6543f80,0x3f5e3f00,0x3f5ebf00,0x2677bf80,0xbf80a742,0xbe853f77,0x3f5e3f00,0x3f35bf35,0x269fbf80,0xbf80a754,0xa6b03f80,0x3f80a60d,0x3f80a60d,0xbe85bf77,0xbf5e3f00,0x3f353f35
.long 0xa6d43f80,0x3f5ebf00,0xbf5ebf00,0xa6f73f80,0xbf80a777,0x3f353f35,0x27c2bf80,0xbf353f35,0x27c2bf80,0xbf003f5e,0x3f5ebf00,0xbf80a78d,0x3f80258d,0xbf77be85,0x3f5e3f00,0xbf35bf35
.long 0xa71f3f80,0x27d4bf80,0xa7303f80,0xa68dbf80,0xbf80a796,0x3f77be85,0xbf5e3f00,0x3f35bf35,0xa68dbf80,0x3f003f5e,0xbf5ebf00,0x3f802816,0x3f80268d,0xbf353f35,0xa60ebf80,0x3f353f35
.long 0x80003f80,0x80003f80,0x0,0x0,0xbf5e3f00,0xbf773e85,0x0,0x0,0xbf5ebf00,0xbf00bf5e,0x0,0x0,0xa50dbf80,0x3f35bf35,0x0,0x0
.long 0x3f5ebf00,0x3f5e3f00,0x0,0x0,0x3f5e3f00,0xbe853f77,0x0,0x0,0x258d3f80,0xbf8025b0,0x0,0x0,0xbf5e3f00,0xbe85bf77,0x0,0x0
.long 0xbf5ebf00,0x3f5ebf00,0x0,0x0,0xa5d4bf80,0x3f353f35,0x0,0x0,0x3f5ebf00,0xbf003f5e,0x0,0x0,0x3f5e3f00,0xbf77be85,0x0,0x0
.long 0x260d3f80,0xa630bf80,0x0,0x0,0xbf5e3f00,0x3f77be85,0x0,0x0,0xbf5ebf00,0x3f003f5e,0x0,0x0,0xa630bf80,0xbf353f35,0x0,0x0
.long 0x80003f80,0x80003f80,0x0,0x0,0xbf00bf5e,0xbe85bf77,0x0,0x0,0x3f5e3f00,0x3f003f5e,0x0,0x0,0xbf8025b0,0xbf35bf35,0x0,0x0
.long 0x3f5ebf00,0x3f5e3f00,0x0,0x0,0xbf003f5e,0xbf77be85,0x0,0x0,0xa630bf80,0x3f80a731,0x0,0x0,0x3f003f5e,0xbf773e85,0x0,0x0
.long 0xbf5ebf00,0x3f5ebf00,0x0,0x0,0x3f80a742,0xbf353f35,0x0,0x0,0xbf5e3f00,0x3f00bf5e,0x0,0x0,0x3f00bf5e,0xbe853f77,0x0,0x0
.long 0x26b03f80,0xa7b1bf80,0x0,0x0,0xbf00bf5e,0x3e853f77,0x0,0x0,0x3f5e3f00,0xbf00bf5e,0x0,0x0,0xbf80a58e,0x3f353f35,0x0,0x0
.long 0x3f80,0x3f80,0x0,0x0,0xbf5ebf00,0xbf77be85,0x0,0x0,0x3f5ebf00,0x3f00bf5e,0x0,0x0,0xa60d3f80,0x3f353f35,0x0,0x0
.long 0xbf5ebf00,0xbf5e3f00,0x0,0x0,0x3f5ebf00,0xbe85bf77,0x0,0x0,0xa68d3f80,0x3f80a654,0x0,0x0,0xbf5ebf00,0xbe853f77,0x0,0x0
.long 0x3f5ebf00,0xbf5ebf00,0x0,0x0,0xa6d43f80,0x3f35bf35,0x0,0x0,0xbf5ebf00,0x3f003f5e,0x0,0x0,0x3f5ebf00,0xbf773e85,0x0,0x0
.long 0xa70d3f80,0xa6d4bf80,0x0,0x0,0xbf5ebf00,0x3f773e85,0x0,0x0,0x3f5ebf00,0xbf003f5e,0x0,0x0,0xa7303f80,0xbf35bf35,0x0,0x0
.long 0x3f80,0x3f80,0x0,0x0,0xbf003f5e,0xbe853f77,0x0,0x0,0xbf5e3f00,0xbf003f5e,0x0,0x0,0xbf80a731,0xbf353f35,0x0,0x0
.long 0xbf5ebf00,0xbf5e3f00,0x0,0x0,0xbf00bf5e,0xbf773e85,0x0,0x0,0x27b1bf80,0xbf80a765,0x0,0x0,0x3f00bf5e,0xbf77be85,0x0,0x0
.long 0x3f5ebf00,0xbf5ebf00,0x0,0x0,0x3f80258d,0xbf35bf35,0x0,0x0,0x3f5e3f00,0xbf00bf5e,0x0,0x0,0x3f003f5e,0xbe85bf77,0x0,0x0
.long 0xa8313f80,0x27e5bf80,0x0,0x0,0xbf003f5e,0x3e85bf77,0x0,0x0,0xbf5e3f00,0x3f00bf5e,0x0,0x0,0xbf80270d,0x3f35bf35,0x0,0x0
.long 0x80003f80,0x3f5ebf00,0xbf5ebf00,0x260d3f80,0x80003f80,0x3f77be85,0xbf00bf5e,0xbf353f35,0x80003f80,0x3f80a554,0xa5d4bf80,0xbf80261f,0x80003f80,0x3f773e85,0x3f00bf5e,0xbf35bf35
.long 0x80003f80,0x3f5e3f00,0x3f5ebf00,0xa630bf80,0x80003f80,0x3f353f35,0x3f80a5f7,0x3f35bf35,0x80003f80,0x3f003f5e,0x3f5e3f00,0x3f80a731,0x80003f80,0x3e853f77,0x3f003f5e,0x3f353f35
.long 0x80000000,0x8000,0x80008000,0x0,0x80000000,0x8000,0x80008000,0x80000000,0x80000000,0x8000,0x80008000,0x80000000,0x80000000,0x0,0x8000,0x80008000
.long 0x80000000,0x0,0x8000,0x80008000,0x80000000,0x0,0x8000,0x8000,0x80000000,0x0,0x0,0x8000,0x80000000,0x0,0x0,0x0
.long 0x268d3f80,0x3f5ebf00,0xbf5ebf00,0x26d43f80,0xbf80a654,0x3e853f77,0x3f5ebf00,0xbf35bf35,0xa69fbf80,0xbf80a60d,0x26d43f80,0x3f80a777,0x3f80a754,0x3e85bf77,0xbf5ebf00,0xbf353f35
.long 0x26b03f80,0x3f5e3f00,0x3f5ebf00,0xa7c2bf80,0xbf80a60d,0xbf353f35,0x26f73f80,0x3f353f35,0xa7b1bf80,0xbf00bf5e,0xbf5ebf00,0xbf80258d,0x3f80a765,0x3f77be85,0x3f5ebf00,0x3f35bf35
.long 0x0,0x8000,0x80008000,0x0,0x80008000,0x0,0x8000,0x80008000,0x80008000,0x80008000,0x0,0x8000,0x8000,0x8000,0x80008000,0x80000000
.long 0x0,0x0,0x8000,0x80008000,0x80008000,0x80000000,0x0,0x0,0x80008000,0x80008000,0x80008000,0x80000000,0x8000,0x8000,0x8000,0x8000
.long 0xa70d3f80,0xbf5ebf00,0x3f5ebf00,0xa7303f80,0xa6d4bf80,0x3f773e85,0xbf003f5e,0xbf35bf35,0xa71f3f80,0xbf80a796,0xa68dbf80,0x3f80268d,0x27d4bf80,0x3f77be85,0x3f003f5e,0xbf353f35
.long 0xa7303f80,0xbf5e3f00,0xbf5ebf00,0xa60ebf80,0xa68dbf80,0x3f35bf35,0x3f802816,0x3f353f35,0xa8313f80,0xbf003f5e,0xbf5e3f00,0xbf80270d,0x27e5bf80,0x3e85bf77,0x3f00bf5e,0x3f35bf35
.long 0x80000000,0x80008000,0x8000,0x80000000,0x80008000,0x0,0x80000000,0x80008000,0x80000000,0x80008000,0x80008000,0x0,0x8000,0x8000,0x0,0x80000000
.long 0x80000000,0x80000000,0x80008000,0x80008000,0x80008000,0x8000,0x0,0x0,0x80000000,0x80000000,0x80000000,0x80000000,0x8000,0x8000,0x8000,0x8000
.long 0xa7543f80,0xbf5ebf00,0x3f5ebf00,0xa7773f80,0xbf80a7b1,0x3e85bf77,0x3f5e3f00,0xbf353f35,0x27f7bf80,0x3f80281f,0xa8423f80,0xbf8026d4,0x3f80281f,0x3e853f77,0xbf5e3f00,0xbf35bf35
.long 0xa8423f80,0xbf5e3f00,0xbf5ebf00,0x280dbf80,0xbf8026d4,0xbf35bf35,0x280dbf80,0x3f35bf35,0x260dbf80,0x3f00bf5e,0x3f5ebf00,0x3f802754,0x3f802730,0x3f773e85,0x3f5e3f00,0x3f353f35
.long 0x80000000,0x80008000,0x8000,0x80000000,0x80008000,0x8000,0x0,0x80000000,0x8000,0x0,0x80000000,0x80000000,0x0,0x0,0x80000000,0x80008000
.long 0x80000000,0x80000000,0x80008000,0x8000,0x80000000,0x80008000,0x8000,0x8000,0x8000,0x8000,0x8000,0x0,0x0,0x0,0x0,0x0
.long 0x3f5ebf00,0xbf5ebf00,0x0,0x0,0x3f5e3f00,0x3e85bf77,0x0,0x0,0x26543f80,0x3f80a742,0x0,0x0,0xbf5e3f00,0x3e853f77,0x0,0x0
.long 0xbf5ebf00,0xbf5e3f00,0x0,0x0,0xa677bf80,0xbf35bf35,0x0,0x0,0x3f5ebf00,0x3f00bf5e,0x0,0x0,0x3f5e3f00,0x3f773e85,0x0,0x0
.long 0x8000,0x80008000,0x0,0x0,0x0,0x8000,0x0,0x0,0x0,0x8000,0x0,0x0,0x80000000,0x0,0x0,0x0
.long 0x80008000,0x80000000,0x0,0x0,0x80008000,0x80008000,0x0,0x0,0x8000,0x8000,0x0,0x0,0x0,0x0,0x0,0x0
.long 0x3f5ebf00,0xbf5ebf00,0x0,0x0,0xbf003f5e,0x3f773e85,0x0,0x0,0xa7c2bf80,0xbf80258d,0x0,0x0,0x3f003f5e,0x3f77be85,0x0,0x0
.long 0xbf5ebf00,0xbf5e3f00,0x0,0x0,0x3f80a78d,0x3f35bf35,0x0,0x0,0xbf5e3f00,0xbf003f5e,0x0,0x0,0x3f00bf5e,0x3e85bf77,0x0,0x0
.long 0x8000,0x80008000,0x0,0x0,0x80000000,0x0,0x0,0x0,0x80008000,0x80000000,0x0,0x0,0x0,0x8000,0x0,0x0
.long 0x80008000,0x80000000,0x0,0x0,0x8000,0x8000,0x0,0x0,0x80000000,0x80000000,0x0,0x0,0x8000,0x8000,0x0,0x0
.long 0xbf5ebf00,0x3f5ebf00,0x0,0x0,0x3f5ebf00,0x3e853f77,0x0,0x0,0xa7543f80,0xbf80a7b1,0x0,0x0,0xbf5ebf00,0x3e85bf77,0x0,0x0
.long 0x3f5ebf00,0x3f5e3f00,0x0,0x0,0xa7773f80,0xbf353f35,0x0,0x0,0xbf5ebf00,0xbf00bf5e,0x0,0x0,0x3f5ebf00,0x3f77be85,0x0,0x0
.long 0x80008000,0x8000,0x0,0x0,0x8000,0x0,0x0,0x0,0x80000000,0x80008000,0x0,0x0,0x80008000,0x8000,0x0,0x0
.long 0x8000,0x0,0x0,0x0,0x80000000,0x80000000,0x0,0x0,0x80008000,0x80008000,0x0,0x0,0x8000,0x8000,0x0,0x0
.long 0xbf5ebf00,0x3f5ebf00,0x0,0x0,0xbf00bf5e,0x3f77be85,0x0,0x0,0x260dbf80,0x3f802730,0x0,0x0,0x3f00bf5e,0x3f773e85,0x0,0x0
.long 0x3f5ebf00,0x3f5e3f00,0x0,0x0,0x3f802754,0x3f353f35,0x0,0x0,0x3f5e3f00,0x3f003f5e,0x0,0x0,0x3f003f5e,0x3e853f77,0x0,0x0
.long 0x80008000,0x8000,0x0,0x0,0x80008000,0x8000,0x0,0x0,0x8000,0x0,0x0,0x0,0x8000,0x0,0x0,0x0
.long 0x8000,0x0,0x0,0x0,0x0,0x0,0x0,0x0,0x0,0x0,0x0,0x0,0x0,0x0,0x0,0x0
.long 0x80000000,0x8000,0x80008000,0x0,0x80000000,0x8000,0x80008000,0x80000000,0x80000000,0x8000,0x80008000,0x80000000,0x80000000,0x0,0x8000,0x80008000
.long 0x80000000,0x0,0x8000,0x80008000,0x80000000,0x0,0x8000,0x8000,0x80000000,0x0,0x0,0x8000,0x80000000,0x0,0x0,0x0
.long 0x80003f80,0x3f5ebf00,0xbf5ebf00,0x260d3f80,0x80003f80,0x3f77be85,0xbf00bf5e,0xbf353f35,0x80003f80,0x3f80a554,0xa5d4bf80,0xbf80261f,0x80003f80,0x3f773e85,0x3f00bf5e,0xbf35bf35
.long 0x80003f80,0x3f5e3f00,0x3f5ebf00,0xa630bf80,0x80003f80,0x3f353f35,0x3f80a5f7,0x3f35bf35,0x80003f80,0x3f003f5e,0x3f5e3f00,0x3f80a731,0x80003f80,0x3e853f77,0x3f003f5e,0x3f353f35
.long 0x0,0x8000,0x80008000,0x0,0x80008000,0x0,0x8000,0x80008000,0x80008000,0x80008000,0x0,0x8000,0x8000,0x8000,0x80008000,0x80000000
.long 0x0,0x0,0x8000,0x80008000,0x80008000,0x80000000,0x0,0x0,0x80008000,0x80008000,0x80008000,0x80000000,0x8000,0x8000,0x8000,0x8000
.long 0x268d3f80,0x3f5ebf00,0xbf5ebf00,0x26d43f80,0xbf80a654,0x3e853f77,0x3f5ebf00,0xbf35bf35,0xa69fbf80,0xbf80a60d,0x26d43f80,0x3f80a777,0x3f80a754,0x3e85bf77,0xbf5ebf00,0xbf353f35
.long 0x26b03f80,0x3f5e3f00,0x3f5ebf00,0xa7c2bf80,0xbf80a60d,0xbf353f35,0x26f73f80,0x3f353f35,0xa7b1bf80,0xbf00bf5e,0xbf5ebf00,0xbf80258d,0x3f80a765,0x3f77be85,0x3f5ebf00,0x3f35bf35
.long 0x80000000,0x80008000,0x8000,0x80000000,0x80008000,0x0,0x80000000,0x80008000,0x80000000,0x80008000,0x80008000,0x0,0x8000,0x8000,0x0,0x80000000
.long 0x80000000,0x80000000,0x80008000,0x80008000,0x80008000,0x8000,0x0,0x0,0x80000000,0x80000000,0x80000000,0x80000000,0x8000,0x8000,0x8000,0x8000
.long 0xa70d3f80,0xbf5ebf00,0x3f5ebf00,0xa7303f80,0xa6d4bf80,0x3f773e85,0xbf003f5e,0xbf35bf35,0xa71f3f80,0xbf80a796,0xa68dbf80,0x3f80268d,0x27d4bf80,0x3f77be85,0x3f003f5e,0xbf353f35
.long 0xa7303f80,0xbf5e3f00,0xbf5ebf00,0xa60ebf80,0xa68dbf80,0x3f35bf35,0x3f802816,0x3f353f35,0xa8313f80,0xbf003f5e,0xbf5e3f00,0xbf80270d,0x27e5bf80,0x3e85bf77,0x3f00bf5e,0x3f35bf35
.long 0x80000000,0x80008000,0x8000,0x80000000,0x80008000,0x8000,0x0,0x80000000,0x8000,0x0,0x80000000,0x80000000,0x0,0x0,0x80000000,0x80008000
.long 0x80000000,0x80000000,0x80008000,0x8000,0x80000000,0x80008000,0x8000,0x8000,0x8000,0x8000,0x8000,0x0,0x0,0x0,0x0,0x0
.long 0xa7543f80,0xbf5ebf00,0x3f5ebf00,0xa7773f80,0xbf80a7b1,0x3e85bf77,0x3f5e3f00,0xbf353f35,0x27f7bf80,0x3f80281f,0xa8423f80,0xbf8026d4,0x3f80281f,0x3e853f77,0xbf5e3f00,0xbf35bf35
.long 0xa8423f80,0xbf5e3f00,0xbf5ebf00,0x280dbf80,0xbf8026d4,0xbf35bf35,0x280dbf80,0x3f35bf35,0x260dbf80,0x3f00bf5e,0x3f5ebf00,0x3f802754,0x3f802730,0x3f773e85,0x3f5e3f00,0x3f353f35
.long 0x8000,0x80008000,0x0,0x0,0x0,0x8000,0x0,0x0,0x0,0x8000,0x0,0x0,0x80000000,0x0,0x0,0x0
.long 0x80008000,0x80000000,0x0,0x0,0x80008000,0x80008000,0x0,0x0,0x8000,0x8000,0x0,0x0,0x0,0x0,0x0,0x0
.long 0x3f5ebf00,0xbf5ebf00,0x0,0x0,0x3f5e3f00,0x3e85bf77,0x0,0x0,0x26543f80,0x3f80a742,0x0,0x0,0xbf5e3f00,0x3e853f77,0x0,0x0
.long 0xbf5ebf00,0xbf5e3f00,0x0,0x0,0xa677bf80,0xbf35bf35,0x0,0x0,0x3f5ebf00,0x3f00bf5e,0x0,0x0,0x3f5e3f00,0x3f773e85,0x0,0x0
.long 0x8000,0x80008000,0x0,0x0,0x80000000,0x0,0x0,0x0,0x80008000,0x80000000,0x0,0x0,0x0,0x8000,0x0,0x0
.long 0x80008000,0x80000000,0x0,0x0,0x8000,0x8000,0x0,0x0,0x80000000,0x80000000,0x0,0x0,0x8000,0x8000,0x0,0x0
.long 0x3f5ebf00,0xbf5ebf00,0x0,0x0,0xbf003f5e,0x3f773e85,0x0,0x0,0xa7c2bf80,0xbf80258d,0x0,0x0,0x3f003f5e,0x3f77be85,0x0,0x0
.long 0xbf5ebf00,0xbf5e3f00,0x0,0x0,0x3f80a78d,0x3f35bf35,0x0,0x0,0xbf5e3f00,0xbf003f5e,0x0,0x0,0x3f00bf5e,0x3e85bf77,0x0,0x0
.long 0x80008000,0x8000,0x0,0x0,0x8000,0x0,0x0,0x0,0x80000000,0x80008000,0x0,0x0,0x80008000,0x8000,0x0,0x0
.long 0x8000,0x0,0x0,0x0,0x80000000,0x80000000,0x0,0x0,0x80008000,0x80008000,0x0,0x0,0x8000,0x8000,0x0,0x0
.long 0xbf5ebf00,0x3f5ebf00,0x0,0x0,0x3f5ebf00,0x3e853f77,0x0,0x0,0xa7543f80,0xbf80a7b1,0x0,0x0,0xbf5ebf00,0x3e85bf77,0x0,0x0
.long 0x3f5ebf00,0x3f5e3f00,0x0,0x0,0xa7773f80,0xbf353f35,0x0,0x0,0xbf5ebf00,0xbf00bf5e,0x0,0x0,0x3f5ebf00,0x3f77be85,0x0,0x0
.long 0x80008000,0x8000,0x0,0x0,0x80008000,0x8000,0x0,0x0,0x8000,0x0,0x0,0x0,0x8000,0x0,0x0,0x0
.long 0x8000,0x0,0x0,0x0,0x0,0x0,0x0,0x0,0x0,0x0,0x0,0x0,0x0,0x0,0x0,0x0
.long 0xbf5ebf00,0x3f5ebf00,0x0,0x0,0xbf00bf5e,0x3f77be85,0x0,0x0,0x260dbf80,0x3f802730,0x0,0x0,0x3f00bf5e,0x3f773e85,0x0,0x0
.long 0x3f5ebf00,0x3f5e3f00,0x0,0x0,0x3f802754,0x3f353f35,0x0,0x0,0x3f5e3f00,0x3f003f5e,0x0,0x0,0x3f003f5e,0x3e853f77,0x0,0x0
.long 0x3f800000,0x3f800000,0x3f800000,0x3f800000,0x3f800000,0x3f773e85,0x3f5e3f00,0x3f353f35,0x3f800000,0x3f5e3f00,0x3f003f5e,0x248d3f80,0x3f800000,0x3f353f35,0x248d3f80,0xbf353f35
.long 0x3f800000,0x3f003f5e,0xbf003f5e,0xbf80250d,0x3f800000,0x3e853f77,0xbf5e3f00,0xbf35bf35,0x3f800000,0x248d3f80,0xbf80250d,0xa554bf80,0x3f800000,0xbe853f77,0xbf5ebf00,0x3f35bf35
.long 0x3f800000,0xbf003f5e,0xbf00bf5e,0x3f80a58d,0x3f800000,0xbf353f35,0xa554bf80,0x3f353f35,0x3f800000,0xbf5e3f00,0x3f00bf5e,0x25b03f80,0x3f800000,0xbf773e85,0x3f5ebf00,0xbf353f35
.long 0x3f800000,0xbf80250d,0x3f80a58d,0xbf8025d4,0x3f800000,0xbf77be85,0x3f5e3f00,0xbf35bf35,0x3f800000,0xbf5ebf00,0x3f003f5e,0xa5f7bf80,0x3f800000,0xbf35bf35,0x25b03f80,0x3f35bf35
.long 0x3f800000,0x3f800000,0x3f800000,0x3f800000,0x248d3f80,0xbe853f77,0xbf003f5e,0xbf353f35,0xbf80250d,0xbf5ebf00,0xbf00bf5e,0xa554bf80,0xa554bf80,0x3f35bf35,0x3f80a58d,0x3f353f35
.long 0x3f80a58d,0x3f003f5e,0xbf003f5e,0xbf8025d4,0x25b03f80,0xbf773e85,0xbf00bf5e,0x3f35bf35,0xbf8025d4,0xa5f7bf80,0x3f80a60d,0x261f3f80,0xa5f7bf80,0x3f773e85,0xbf003f5e,0xbf35bf35
.long 0x3f80a60d,0xbf003f5e,0xbf00bf5e,0x3f80a654,0x261f3f80,0xbf35bf35,0x3f80a654,0xbf353f35,0xbf802630,0x3f5ebf00,0xbf003f5e,0xa742bf80,0xa731bf80,0x3e853f77,0xbf00bf5e,0x3f353f35
.long 0x3f80a654,0xbf802677,0x3f80a68d,0xbf80269f,0xa68d3f80,0x3e85bf77,0xbf003f5e,0x3f35bf35,0xbf802677,0x3f5e3f00,0xbf00bf5e,0xa60d3f80,0xa742bf80,0xbf353f35,0x3f80a6b0,0xbf35bf35
.long 0xbf800000,0xbf800000,0xbf800000,0xbf800000,0x3f80250d,0x3f77be85,0x3f5ebf00,0x3f35bf35,0xbf80a58d,0xbf5e3f00,0xbf003f5e,0xa5b03f80,0x3f8025d4,0x3f35bf35,0x25f7bf80,0xbf35bf35
.long 0xbf80a60d,0xbf003f5e,0x3f003f5e,0x3f802630,0x3f802630,0x3e85bf77,0xbf5ebf00,0xbf353f35,0xbf80a654,0x268d3f80,0x3f802677,0x2742bf80,0x3f802677,0xbe85bf77,0xbf5e3f00,0x3f353f35
.long 0xbf80a68d,0x3f003f5e,0x3f00bf5e,0xbf80a6b0,0x3f80269f,0xbf35bf35,0x260d3f80,0x3f35bf35,0xbf80a6b0,0x3f5e3f00,0xbf00bf5e,0x258e3f80,0x3f8027b1,0xbf77be85,0x3f5e3f00,0xbf35bf35
.long 0xbf80a6d4,0x3f80a70d,0xbf80a6f7,0x3f8027c2,0x3f80a70d,0xbf773e85,0x3f5ebf00,0xbf353f35,0xbf80a6f7,0x3f5ebf00,0xbf003f5e,0x278dbf80,0x3f8027c2,0xbf353f35,0x278dbf80,0x3f353f35
.long 0xbf800000,0xbf800000,0xbf800000,0xbf800000,0x2554bf80,0xbe85bf77,0xbf00bf5e,0xbf35bf35,0x3f8025d4,0x3f5ebf00,0x3f00bf5e,0x25f7bf80,0xa61f3f80,0x3f353f35,0x3f802630,0x3f35bf35
.long 0xbf80a654,0xbf003f5e,0x3f003f5e,0x3f802677,0x2742bf80,0xbf77be85,0xbf003f5e,0x3f353f35,0x3f80269f,0x2754bf80,0xbf80a6b0,0x260d3f80,0x260d3f80,0x3f77be85,0xbf00bf5e,0xbf353f35
.long 0xbf80a6d4,0x3f003f5e,0x3f00bf5e,0xbf80a6f7,0x2777bf80,0xbf353f35,0x3f8027c2,0xbf35bf35,0x3f8027c2,0xbf5ebf00,0x3f003f5e,0x278dbf80,0xa58d3f80,0x3e85bf77,0xbf003f5e,0x3f35bf35
.long 0xbf80a71f,0x3f8027d4,0xbf80a730,0x3f80a68d,0x2796bf80,0x3e853f77,0xbf00bf5e,0x3f353f35,0x3f80a68d,0xbf5e3f00,0x3f00bf5e,0xa8163f80,0xa68d3f80,0xbf35bf35,0x3f80a60e,0xbf353f35
.long 0x3f800000,0x3f800000,0x0,0x0,0x3f003f5e,0x3e853f77,0x0,0x0,0xbf003f5e,0xbf5e3f00,0x0,0x0,0xbf80250d,0xbf35bf35,0x0,0x0
.long 0xbf00bf5e,0x3f00bf5e,0x0,0x0,0x3f00bf5e,0x3f773e85,0x0,0x0,0x3f80a58d,0x25b03f80,0x0,0x0,0x3f003f5e,0xbf773e85,0x0,0x0
.long 0xbf003f5e,0xbf00bf5e,0x0,0x0,0xbf8025d4,0x3f35bf35,0x0,0x0,0xbf00bf5e,0x3f5e3f00,0x0,0x0,0x3f00bf5e,0xbe853f77,0x0,0x0
.long 0x3f80a60d,0xbf802630,0x0,0x0,0x3f003f5e,0xbe85bf77,0x0,0x0,0xbf003f5e,0x3f5ebf00,0x0,0x0,0xbf802630,0x3f353f35,0x0,0x0
.long 0x3f800000,0x3f800000,0x0,0x0,0xbf5e3f00,0xbf773e85,0x0,0x0,0x3f00bf5e,0x3f5ebf00,0x0,0x0,0x25b03f80,0xbf353f35,0x0,0x0
.long 0xbf00bf5e,0x3f00bf5e,0x0,0x0,0x3f5e3f00,0xbe853f77,0x0,0x0,0xbf802630,0xa731bf80,0x0,0x0,0x3f5ebf00,0x3e853f77,0x0,0x0
.long 0xbf003f5e,0xbf00bf5e,0x0,0x0,0xa742bf80,0x3f353f35,0x0,0x0,0x3f003f5e,0xbf5ebf00,0x0,0x0,0xbf5ebf00,0x3f773e85,0x0,0x0
.long 0x3f80a6b0,0xbf8027b1,0x0,0x0,0xbf5e3f00,0x3f77be85,0x0,0x0,0x3f00bf5e,0xbf5e3f00,0x0,0x0,0xa58e3f80,0x3f35bf35,0x0,0x0
.long 0xbf800000,0xbf800000,0x0,0x0,0x3f00bf5e,0x3e85bf77,0x0,0x0,0x3f003f5e,0x3f5e3f00,0x0,0x0,0xbf80a60d,0xbf353f35,0x0,0x0
.long 0x3f00bf5e,0xbf00bf5e,0x0,0x0,0x3f003f5e,0x3f77be85,0x0,0x0,0xbf80a68d,0x26543f80,0x0,0x0,0x3f00bf5e,0xbf77be85,0x0,0x0
.long 0x3f003f5e,0x3f00bf5e,0x0,0x0,0xbf80a6d4,0x3f353f35,0x0,0x0,0x3f00bf5e,0xbf5e3f00,0x0,0x0,0x3f003f5e,0xbe85bf77,0x0,0x0
.long 0xbf80a70d,0x3f80a6d4,0x0,0x0,0x3f00bf5e,0xbe853f77,0x0,0x0,0x3f003f5e,0xbf5ebf00,0x0,0x0,0xbf80a730,0x3f35bf35,0x0,0x0
.long 0xbf800000,0xbf800000,0x0,0x0,0xbf5ebf00,0xbf77be85,0x0,0x0,0xbf00bf5e,0xbf5ebf00,0x0,0x0,0x2731bf80,0xbf35bf35,0x0,0x0
.long 0x3f00bf5e,0xbf00bf5e,0x0,0x0,0x3f5ebf00,0xbe85bf77,0x0,0x0,0x3f8027b1,0x2765bf80,0x0,0x0,0x3f5e3f00,0x3e85bf77,0x0,0x0
.long 0x3f003f5e,0x3f00bf5e,0x0,0x0,0xa58d3f80,0x3f35bf35,0x0,0x0,0xbf003f5e,0x3f5ebf00,0x0,0x0,0xbf5e3f00,0x3f77be85,0x0,0x0
.long 0xbf80a831,0x3f8027e5,0x0,0x0,0xbf5ebf00,0x3f773e85,0x0,0x0,0xbf00bf5e,0x3f5e3f00,0x0,0x0,0xa70dbf80,0x3f353f35,0x0,0x0
.long 0x3f800000,0xbf00bf5e,0xbf003f5e,0x3f80a60d,0x3f800000,0xbe85bf77,0xbf5e3f00,0x3f353f35,0x3f800000,0xa554bf80,0xbf8025d4,0x261f3f80,0x3f800000,0x3e85bf77,0xbf5ebf00,0xbf353f35
.long 0x3f800000,0x3f00bf5e,0xbf00bf5e,0xbf802630,0x3f800000,0x3f35bf35,0xa5f7bf80,0xbf35bf35,0x3f800000,0x3f5ebf00,0x3f00bf5e,0xa731bf80,0x3f800000,0x3f77be85,0x3f5ebf00,0x3f35bf35
.long 0x0,0x80008000,0x80000000,0x8000,0x0,0x80008000,0x80000000,0x0,0x0,0x80008000,0x80000000,0x0,0x0,0x8000,0x80008000,0x80000000
.long 0x0,0x8000,0x80008000,0x80000000,0x0,0x8000,0x80008000,0x80008000,0x0,0x8000,0x8000,0x80008000,0x0,0x8000,0x8000,0x8000
.long 0x3f80a68d,0xbf00bf5e,0xbf003f5e,0x3f80a6d4,0xa6543f80,0x3f77be85,0xbf00bf5e,0xbf353f35,0xbf80269f,0xa60d3f80,0x3f80a6d4,0xa777bf80,0xa754bf80,0xbf77be85,0xbf003f5e,0x3f353f35
.long 0x3f80a6b0,0x3f00bf5e,0xbf00bf5e,0xbf8027c2,0xa60d3f80,0x3f353f35,0x3f80a6f7,0x3f35bf35,0xbf8027b1,0xbf5e3f00,0xbf003f5e,0x258d3f80,0xa765bf80,0xbe85bf77,0xbf00bf5e,0xbf35bf35
.long 0x8000,0x80008000,0x80000000,0x8000,0x80000000,0x8000,0x80008000,0x80000000,0x80000000,0x80000000,0x8000,0x80008000,0x80008000,0x80008000,0x80000000,0x0
.long 0x8000,0x8000,0x80008000,0x80000000,0x80000000,0x0,0x8000,0x8000,0x80000000,0x80000000,0x80000000,0x0,0x80008000,0x80008000,0x80008000,0x80008000
.long 0xbf80a70d,0x3f00bf5e,0x3f003f5e,0xbf80a730,0x3f80a6d4,0xbe853f77,0xbf5ebf00,0x3f35bf35,0xbf80a71f,0x2796bf80,0x3f80a68d,0xa68d3f80,0x3f8027d4,0x3e853f77,0xbf5e3f00,0xbf35bf35
.long 0xbf80a730,0xbf00bf5e,0x3f00bf5e,0x3f80a60e,0x3f80a68d,0x3f353f35,0xa8163f80,0xbf353f35,0xbf80a831,0xbf5ebf00,0xbf00bf5e,0xa70dbf80,0x3f8027e5,0x3f773e85,0x3f5e3f00,0x3f353f35
.long 0x80008000,0x8000,0x0,0x80008000,0x8000,0x80000000,0x80008000,0x8000,0x80008000,0x8000,0x8000,0x80000000,0x0,0x0,0x80000000,0x80008000
.long 0x80008000,0x80008000,0x8000,0x8000,0x8000,0x0,0x80000000,0x80000000,0x80008000,0x80008000,0x80008000,0x80008000,0x0,0x0,0x0,0x0
.long 0xbf80a754,0x3f00bf5e,0x3f003f5e,0xbf80a777,0x27b1bf80,0x3f773e85,0xbf003f5e,0xbf35bf35,0x3f8027f7,0xa81f3f80,0xbf80a842,0xa6d4bf80,0xa81f3f80,0xbf773e85,0xbf00bf5e,0x3f35bf35
.long 0xbf80a842,0xbf00bf5e,0x3f00bf5e,0x3f80280d,0xa6d4bf80,0x3f35bf35,0x3f80280d,0x3f353f35,0x3f80260d,0x3f5e3f00,0x3f003f5e,0xa7543f80,0xa7303f80,0xbe853f77,0xbf003f5e,0xbf353f35
.long 0x80008000,0x8000,0x0,0x80008000,0x8000,0x0,0x80000000,0x80008000,0x0,0x80000000,0x80008000,0x80008000,0x80000000,0x80000000,0x80008000,0x8000
.long 0x80008000,0x80008000,0x8000,0x0,0x80008000,0x8000,0x0,0x0,0x0,0x0,0x0,0x80000000,0x80000000,0x80000000,0x80000000,0x80000000
.long 0xbf00bf5e,0xbf003f5e,0x0,0x0,0x3f00bf5e,0xbf77be85,0x0,0x0,0x3f80a654,0xa742bf80,0x0,0x0,0x3f003f5e,0x3f77be85,0x0,0x0
.long 0xbf003f5e,0x3f003f5e,0x0,0x0,0xbf802677,0xbf353f35,0x0,0x0,0xbf00bf5e,0xbf5ebf00,0x0,0x0,0x3f00bf5e,0x3e85bf77,0x0,0x0
.long 0x80008000,0x80000000,0x0,0x0,0x8000,0x80008000,0x0,0x0,0x8000,0x80008000,0x0,0x0,0x0,0x8000,0x0,0x0
.long 0x80000000,0x0,0x0,0x0,0x80000000,0x80000000,0x0,0x0,0x80008000,0x80008000,0x0,0x0,0x8000,0x8000,0x0,0x0
.long 0xbf00bf5e,0xbf003f5e,0x0,0x0,0x3f5e3f00,0x3e85bf77,0x0,0x0,0xbf8027c2,0x258d3f80,0x0,0x0,0x3f5ebf00,0xbe85bf77,0x0,0x0
.long 0xbf003f5e,0x3f003f5e,0x0,0x0,0xa78dbf80,0xbf35bf35,0x0,0x0,0x3f003f5e,0x3f5e3f00,0x0,0x0,0xbf5ebf00,0xbf77be85,0x0,0x0
.long 0x80008000,0x80000000,0x0,0x0,0x0,0x8000,0x0,0x0,0x80000000,0x0,0x0,0x0,0x8000,0x80008000,0x0,0x0
.long 0x80000000,0x0,0x0,0x0,0x80008000,0x80008000,0x0,0x0,0x0,0x0,0x0,0x0,0x80008000,0x80008000,0x0,0x0
.long 0x3f00bf5e,0x3f003f5e,0x0,0x0,0x3f003f5e,0xbf773e85,0x0,0x0,0xbf80a754,0x27b1bf80,0x0,0x0,0x3f00bf5e,0x3f773e85,0x0,0x0
.long 0x3f003f5e,0xbf003f5e,0x0,0x0,0xbf80a777,0xbf35bf35,0x0,0x0,0x3f00bf5e,0x3f5ebf00,0x0,0x0,0x3f003f5e,0x3e853f77,0x0,0x0
.long 0x8000,0x0,0x0,0x0,0x0,0x80000000,0x0,0x0,0x80008000,0x8000,0x0,0x0,0x8000,0x0,0x0,0x0
.long 0x0,0x80000000,0x0,0x0,0x80008000,0x80008000,0x0,0x0,0x8000,0x8000,0x0,0x0,0x0,0x0,0x0,0x0
.long 0x3f00bf5e,0x3f003f5e,0x0,0x0,0x3f5ebf00,0x3e853f77,0x0,0x0,0x3f80260d,0xa7303f80,0x0,0x0,0x3f5e3f00,0xbe853f77,0x0,0x0
.long 0x3f003f5e,0xbf003f5e,0x0,0x0,0xa7543f80,0xbf353f35,0x0,0x0,0xbf003f5e,0xbf5e3f00,0x0,0x0,0xbf5e3f00,0xbf773e85,0x0,0x0
.long 0x8000,0x0,0x0,0x0,0x8000,0x0,0x0,0x0,0x0,0x80000000,0x0,0x0,0x0,0x80000000,0x0,0x0
.long 0x0,0x80000000,0x0,0x0,0x80000000,0x80000000,0x0,0x0,0x80000000,0x80000000,0x0,0x0,0x80000000,0x80000000,0x0,0x0
.long 0x0,0x80008000,0x80000000,0x8000,0x0,0x80008000,0x80000000,0x0,0x0,0x80008000,0x80000000,0x0,0x0,0x8000,0x80008000,0x80000000
.long 0x0,0x8000,0x80008000,0x80000000,0x0,0x8000,0x80008000,0x80008000,0x0,0x8000,0x8000,0x80008000,0x0,0x8000,0x8000,0x8000
.long 0x3f800000,0xbf00bf5e,0xbf003f5e,0x3f80a60d,0x3f800000,0xbe85bf77,0xbf5e3f00,0x3f353f35,0x3f800000,0xa554bf80,0xbf8025d4,0x261f3f80,0x3f800000,0x3e85bf77,0xbf5ebf00,0xbf353f35
.long 0x3f800000,0x3f00bf5e,0xbf00bf5e,0xbf802630,0x3f800000,0x3f35bf35,0xa5f7bf80,0xbf35bf35,0x3f800000,0x3f5ebf00,0x3f00bf5e,0xa731bf80,0x3f800000,0x3f77be85,0x3f5ebf00,0x3f35bf35
.long 0x8000,0x80008000,0x80000000,0x8000,0x80000000,0x8000,0x80008000,0x80000000,0x80000000,0x80000000,0x8000,0x80008000,0x80008000,0x80008000,0x80000000,0x0
.long 0x8000,0x8000,0x80008000,0x80000000,0x80000000,0x0,0x8000,0x8000,0x80000000,0x80000000,0x80000000,0x0,0x80008000,0x80008000,0x80008000,0x80008000
.long 0x3f80a68d,0xbf00bf5e,0xbf003f5e,0x3f80a6d4,0xa6543f80,0x3f77be85,0xbf00bf5e,0xbf353f35,0xbf80269f,0xa60d3f80,0x3f80a6d4,0xa777bf80,0xa754bf80,0xbf77be85,0xbf003f5e,0x3f353f35
.long 0x3f80a6b0,0x3f00bf5e,0xbf00bf5e,0xbf8027c2,0xa60d3f80,0x3f353f35,0x3f80a6f7,0x3f35bf35,0xbf8027b1,0xbf5e3f00,0xbf003f5e,0x258d3f80,0xa765bf80,0xbe85bf77,0xbf00bf5e,0xbf35bf35
.long 0x80008000,0x8000,0x0,0x80008000,0x8000,0x80000000,0x80008000,0x8000,0x80008000,0x8000,0x8000,0x80000000,0x0,0x0,0x80000000,0x80008000
.long 0x80008000,0x80008000,0x8000,0x8000,0x8000,0x0,0x80000000,0x80000000,0x80008000,0x80008000,0x80008000,0x80008000,0x0,0x0,0x0,0x0
.long 0xbf80a70d,0x3f00bf5e,0x3f003f5e,0xbf80a730,0x3f80a6d4,0xbe853f77,0xbf5ebf00,0x3f35bf35,0xbf80a71f,0x2796bf80,0x3f80a68d,0xa68d3f80,0x3f8027d4,0x3e853f77,0xbf5e3f00,0xbf35bf35
.long 0xbf80a730,0xbf00bf5e,0x3f00bf5e,0x3f80a60e,0x3f80a68d,0x3f353f35,0xa8163f80,0xbf353f35,0xbf80a831,0xbf5ebf00,0xbf00bf5e,0xa70dbf80,0x3f8027e5,0x3f773e85,0x3f5e3f00,0x3f353f35
.long 0x80008000,0x8000,0x0,0x80008000,0x8000,0x0,0x80000000,0x80008000,0x0,0x80000000,0x80008000,0x80008000,0x80000000,0x80000000,0x80008000,0x8000
.long 0x80008000,0x80008000,0x8000,0x0,0x80008000,0x8000,0x0,0x0,0x0,0x0,0x0,0x80000000,0x80000000,0x80000000,0x80000000,0x80000000
.long 0xbf80a754,0x3f00bf5e,0x3f003f5e,0xbf80a777,0x27b1bf80,0x3f773e85,0xbf003f5e,0xbf35bf35,0x3f8027f7,0xa81f3f80,0xbf80a842,0xa6d4bf80,0xa81f3f80,0xbf773e85,0xbf00bf5e,0x3f35bf35
.long 0xbf80a842,0xbf00bf5e,0x3f00bf5e,0x3f80280d,0xa6d4bf80,0x3f35bf35,0x3f80280d,0x3f353f35,0x3f80260d,0x3f5e3f00,0x3f003f5e,0xa7543f80,0xa7303f80,0xbe853f77,0xbf003f5e,0xbf353f35
.long 0x80008000,0x80000000,0x0,0x0,0x8000,0x80008000,0x0,0x0,0x8000,0x80008000,0x0,0x0,0x0,0x8000,0x0,0x0
.long 0x80000000,0x0,0x0,0x0,0x80000000,0x80000000,0x0,0x0,0x80008000,0x80008000,0x0,0x0,0x8000,0x8000,0x0,0x0
.long 0xbf00bf5e,0xbf003f5e,0x0,0x0,0x3f00bf5e,0xbf77be85,0x0,0x0,0x3f80a654,0xa742bf80,0x0,0x0,0x3f003f5e,0x3f77be85,0x0,0x0
.long 0xbf003f5e,0x3f003f5e,0x0,0x0,0xbf802677,0xbf353f35,0x0,0x0,0xbf00bf5e,0xbf5ebf00,0x0,0x0,0x3f00bf5e,0x3e85bf77,0x0,0x0
.long 0x80008000,0x80000000,0x0,0x0,0x0,0x8000,0x0,0x0,0x80000000,0x0,0x0,0x0,0x8000,0x80008000,0x0,0x0
.long 0x80000000,0x0,0x0,0x0,0x80008000,0x80008000,0x0,0x0,0x0,0x0,0x0,0x0,0x80008000,0x80008000,0x0,0x0
.long 0xbf00bf5e,0xbf003f5e,0x0,0x0,0x3f5e3f00,0x3e85bf77,0x0,0x0,0xbf8027c2,0x258d3f80,0x0,0x0,0x3f5ebf00,0xbe85bf77,0x0,0x0
.long 0xbf003f5e,0x3f003f5e,0x0,0x0,0xa78dbf80,0xbf35bf35,0x0,0x0,0x3f003f5e,0x3f5e3f00,0x0,0x0,0xbf5ebf00,0xbf77be85,0x0,0x0
.long 0x8000,0x0,0x0,0x0,0x0,0x80000000,0x0,0x0,0x80008000,0x8000,0x0,0x0,0x8000,0x0,0x0,0x0
.long 0x0,0x80000000,0x0,0x0,0x80008000,0x80008000,0x0,0x0,0x8000,0x8000,0x0,0x0,0x0,0x0,0x0,0x0
.long 0x3f00bf5e,0x3f003f5e,0x0,0x0,0x3f003f5e,0xbf773e85,0x0,0x0,0xbf80a754,0x27b1bf80,0x0,0x0,0x3f00bf5e,0x3f773e85,0x0,0x0
.long 0x3f003f5e,0xbf003f5e,0x0,0x0,0xbf80a777,0xbf35bf35,0x0,0x0,0x3f00bf5e,0x3f5ebf00,0x0,0x0,0x3f003f5e,0x3e853f77,0x0,0x0
.long 0x8000,0x0,0x0,0x0,0x8000,0x0,0x0,0x0,0x0,0x80000000,0x0,0x0,0x0,0x80000000,0x0,0x0
.long 0x0,0x80000000,0x0,0x0,0x80000000,0x80000000,0x0,0x0,0x80000000,0x80000000,0x0,0x0,0x80000000,0x80000000,0x0,0x0
.long 0x3f00bf5e,0x3f003f5e,0x0,0x0,0x3f5ebf00,0x3e853f77,0x0,0x0,0x3f80260d,0xa7303f80,0x0,0x0,0x3f5e3f00,0xbe853f77,0x0,0x0
.long 0x3f003f5e,0xbf003f5e,0x0,0x0,0xa7543f80,0xbf353f35,0x0,0x0,0xbf003f5e,0xbf5e3f00,0x0,0x0,0xbf5e3f00,0xbf773e85,0x0,0x0
.long 0x3564d82c,0x3564d82c,0x3564d82c,0x3564d82c,0x3564d82c,0x3564d4b0,0x3564ca3b,0x3564b8ce,0x3564d82c,0x3564ca3b,0x3564a069,0x35645abd,0x3564d82c,0x3564b8ce,0x35645abd,0x3563be13
.long 0x3564d82c,0x3564a069,0x3563f93e,0x3562e2fa,0x3564d82c,0x3564810e,0x35637bf7,0x3561c9af,0x3564d82c,0x35645abd,0x3562e2fa,0x3560727e,0x3564d82c,0x35642d77,0x35622e57,0x355eddc7
.long 0x3564d82c,0x3563f93e,0x35615e25,0x355d0bf7,0x3564d82c,0x3563be13,0x3560727e,0x355afd8e,0x3564d82c,0x35637bf7,0x355f6b7e,0x3558b31e,0x3564d82c,0x356332ee,0x355e4945,0x35562d46
.long 0x3564d82c,0x3562e2fa,0x355d0bf7,0x35536cb7,0x3564d82c,0x35628c1c,0x355bb3ba,0x35507234,0x3564d82c,0x35622e57,0x355a40b8,0x354d3e8c,0x3564d82c,0x3561c9af,0x3558b31e,0x3549d2a0
.long 0x3564d82c,0x3564d82c,0x3564d82c,0x3564d82c,0x3564a069,0x3564810e,0x35645abd,0x35642d77,0x3563f93e,0x35637bf7,0x3562e2fa,0x35622e57,0x3562e2fa,0x3561c9af,0x3560727e,0x355eddc7
.long 0x35615e25,0x355f6b7e,0x355d0bf7,0x355a40b8,0x355f6b7e,0x355c6333,0x3558b31e,0x35545e0c,0x355d0bf7,0x3558b31e,0x35536cb7,0x354d3e8c,0x355a40b8,0x35545e0c,0x354d3e8c,0x3544ecd7
.long 0x35570b1d,0x354f674a,0x35462f61,0x353b7558,0x35536cb7,0x3549d2a0,0x353e46f5,0x3530e62d,0x354f674a,0x3543a44e,0x35358df3,0x35254f18,0x354afccb,0x353ce107,0x352c0de9,0x3518c163
.long 0x35462f61,0x35358df3,0x3521d144,0x350b4fc9,0x35410164,0x352db0a4,0x3516e33a,0x34fa1caf,0x353b7558,0x35254f18,0x350b4fc9,0x34dc24a8,0x35358df3,0x351c6fb0,0x34fe473e,0x34bce433
.long 0x3564d82c,0x3564d82c,0x3564d82c,0x3564d82c,0x3563f93e,0x3563be13,0x35637bf7,0x356332ee,0x35615e25,0x3560727e,0x355f6b7e,0x355e4945,0x355d0bf7,0x355afd8e,0x3558b31e,0x35562d46
.long 0x35570b1d,0x35536cb7,0x354f674a,0x354afccb,0x354f674a,0x3549d2a0,0x3543a44e,0x353ce107,0x35462f61,0x353e46f5,0x35358df3,0x352c0de9,0x353b7558,0x3530e62d,0x35254f18,0x3518c163
.long 0x352f4e14,0x3521d144,0x3513192e,0x35034280,0x3521d144,0x35112d68,0x34fe473e,0x34d7c0c6,0x3513192e,0x34fe473e,0x34d35652,0x34a5e244,0x35034280,0x34d7c0c6,0x34a5e244,0x3463421f
.long 0x34e4d82c,0x34af2662,0x346ceacc,0x33eef626,0x34c16d7b,0x3484dc2d,0x340b4017,0x321fc2a8,0x349c89ef,0x343294d2,0x331fb67e,0xb3c74f01,0x346ceacc,0x33b37206,0xb36f7969,0xb44fdc4c
.long 0x3564d82c,0x3564d82c,0x3564d82c,0x3564d82c,0x3562e2fa,0x35628c1c,0x35622e57,0x3561c9af,0x355d0bf7,0x355bb3ba,0x355a40b8,0x3558b31e,0x35536cb7,0x35507234,0x354d3e8c,0x3549d2a0
.long 0x35462f61,0x35410164,0x353b7558,0x35358df3,0x35358df3,0x352db0a4,0x35254f18,0x351c6fb0,0x3521d144,0x3516e33a,0x350b4fc9,0x34fe473e,0x350b4fc9,0x34fa1caf,0x34dc24a8,0x34bce433
.long 0x34e4d82c,0x34c16d7b,0x349c89ef,0x346ceacc,0x34af2662,0x3484dc2d,0x343294d2,0x33b37206,0x346ceacc,0x340b4017,0x331fb67e,0xb36f7969,0x33eef626,0x321fc2a8,0xb3c74f01,0xb44fdc4c
.long 0x1a7c6e14,0xb3eef626,0xb46ceacc,0xb4af2662,0xb3eef626,0xb4768c41,0xb4b85529,0xb4f1b0d6,0xb46ceacc,0xb4b85529,0xb4f5ea81,0xb516e33a,0xb4af2662,0xb4f1b0d6,0xb516e33a,0xb530e62d
.long 0x0,0x0,0x0,0x0,0x0,0x321fc2a8,0x329fc039,0x32ef9a40,0x0,0x329fc039,0x331fb67e,0x336f7969,0x0,0x32ef9a40,0x336f7969,0x33b37206
.long 0x0,0x331fb67e,0x339f8f93,0x33eef626,0x0,0x33479afd,0x33c74f01,0x34151c63,0x0,0x336f7969,0x33eef626,0x343294d2,0x0,0x338ba844,0x340b4017,0x344fdc4c
.long 0x0,0x339f8f93,0x341ef423,0x346ceacc,0x0,0x33b37206,0x343294d2,0x3484dc2d,0x0,0x33c74f01,0x34461fbe,0x34931e87,0x0,0x33db25ea,0x34599286,0x34a1388e
.long 0x0,0x33eef626,0x346ceacc,0x34af2662,0x0,0x34015f8e,0x3480131a,0x34bce433,0x0,0x340b4017,0x3489a133,0x34ca6e3c,0x0,0x34151c63,0x34931e87,0x34d7c0c6
.long 0x0,0x0,0x0,0x0,0x331fb67e,0x33479afd,0x336f7969,0x338ba844,0x339f8f93,0x33c74f01,0x33eef626,0x340b4017,0x33eef626,0x34151c63,0x343294d2,0x344fdc4c
.long 0x341ef423,0x34461fbe,0x346ceacc,0x3489a133,0x34461fbe,0x34768c41,0x34931e87,0x34aa86ec,0x346ceacc,0x34931e87,0x34af2662,0x34ca6e3c,0x3489a133,0x34aa86ec,0x34ca6e3c,0x34e9278a
.long 0x349c89ef,0x34c16d7b,0x34e4d82c,0x35034280,0x34af2662,0x34d7c0c6,0x34fe473e,0x35112d68,0x34c16d7b,0x34ed6fcd,0x350b4fc9,0x351e3fb8,0x34d35652,0x35013507,0x3516e33a,0x352a65f1
.long 0x34e4d82c,0x350b4fc9,0x3521d144,0x35358df3,0x34f5ea81,0x35150079,0x352c0de9,0x353fa718,0x35034280,0x351e3fb8,0x35358df3,0x3548a24f,0x350b4fc9,0x3527067b,0x353e46f5,0x35507234
.long 0x0,0x0,0x0,0x0,0x339f8f93,0x33b37206,0x33c74f01,0x33db25ea,0x341ef423,0x343294d2,0x34461fbe,0x34599286,0x346ceacc,0x3484dc2d,0x34931e87,0x34a1388e
.long 0x349c89ef,0x34af2662,0x34c16d7b,0x34d35652,0x34c16d7b,0x34d7c0c6,0x34ed6fcd,0x35013507,0x34e4d82c,0x34fe473e,0x350b4fc9,0x3516e33a,0x35034280,0x35112d68,0x351e3fb8,0x352a65f1
.long 0x3513192e,0x3521d144,0x352f4e14,0x353b7558,0x3521d144,0x3530e62d,0x353e46f5,0x3549d2a0,0x352f4e14,0x353e46f5,0x354afccb,0x355548e9,0x353b7558,0x3549d2a0,0x355548e9,0x355dadfe
.long 0x35462f61,0x35536cb7,0x355d0bf7,0x3562e2fa,0x354f674a,0x355afd8e,0x35622e57,0x3564d4b0,0x35570b1d,0x3560727e,0x3564a069,0x35637bf7,0x355d0bf7,0x3563be13,0x35645abd,0x355eddc7
.long 0x0,0x0,0x0,0x0,0x33eef626,0x34015f8e,0x340b4017,0x34151c63,0x346ceacc,0x3480131a,0x3489a133,0x34931e87,0x34af2662,0x34bce433,0x34ca6e3c,0x34d7c0c6
.long 0x34e4d82c,0x34f5ea81,0x35034280,0x350b4fc9,0x350b4fc9,0x35150079,0x351e3fb8,0x3527067b,0x3521d144,0x352c0de9,0x35358df3,0x353e46f5,0x35358df3,0x353fa718,0x3548a24f,0x35507234
.long 0x35462f61,0x354f674a,0x35570b1d,0x355d0bf7,0x35536cb7,0x355afd8e,0x3560727e,0x3563be13,0x355d0bf7,0x35622e57,0x3564a069,0x35645abd,0x3562e2fa,0x3564d4b0,0x35637bf7,0x355eddc7
.long 0x3564d82c,0x3562e2fa,0x355d0bf7,0x35536cb7,0x3562e2fa,0x355c6333,0x355176c4,0x354255ce,0x355d0bf7,0x355176c4,0x35410164,0x352c0de9,0x35536cb7,0x354255ce,0x352c0de9,0x35112d68
.long 0x3564d82c,0x35615e25,0x35570b1d,0x35462f61,0x3564d82c,0x3560ebbf,0x355548e9,0x354255ce,0x3564d82c,0x3560727e,0x35536cb7,0x353e46f5,0x3564d82c,0x355ff267,0x355176c4,0x353a03f3
.long 0x3564d82c,0x355f6b7e,0x354f674a,0x35358df3,0x3564d82c,0x355eddc7,0x354d3e8c,0x3530e62d,0x3564d82c,0x355e4945,0x354afccb,0x352c0de9,0x3564d82c,0x355dadfe,0x3548a24f,0x3527067b
.long 0x3564d82c,0x35615e25,0x35570b1d,0x35462f61,0x3564d82c,0x3560ebbf,0x355548e9,0x354255ce,0x3564d82c,0x3560727e,0x35536cb7,0x353e46f5,0x3564d82c,0x355ff267,0x355176c4,0x353a03f3
.long 0x3564d82c,0x355f6b7e,0x354f674a,0x35358df3,0x3564d82c,0x355eddc7,0x354d3e8c,0x3530e62d,0x3564d82c,0x355e4945,0x354afccb,0x352c0de9,0x3564d82c,0x355dadfe,0x3548a24f,0x3527067b
.long 0x352f4e14,0x3513192e,0x34e4d82c,0x349c89ef,0x3528b8c8,0x350952ad,0x34ca6e3c,0x34768c41,0x3521d144,0x34fe473e,0x34af2662,0x343294d2,0x351a9ae4,0x34e9278a,0x34931e87,0x33db25ea
.long 0x3513192e,0x34d35652,0x346ceacc,0x331fb67e,0x350b4fc9,0x34bce433,0x343294d2,0xb2ef9a40,0x35034280,0x34a5e244,0x33eef626,0xb3c74f01,0x34f5ea81,0x348e6209,0x336f7969,0xb428c70d
.long 0x352f4e14,0x3513192e,0x34e4d82c,0x349c89ef,0x3528b8c8,0x350952ad,0x34ca6e3c,0x34768c41,0x3521d144,0x34fe473e,0x34af2662,0x343294d2,0x351a9ae4,0x34e9278a,0x34931e87,0x33db25ea
.long 0x3513192e,0x34d35652,0x346ceacc,0x331fb67e,0x350b4fc9,0x34bce433,0x343294d2,0xb2ef9a40,0x35034280,0x34a5e244,0x33eef626,0xb3c74f01,0x34f5ea81,0x348e6209,0x336f7969,0xb428c70d
.long 0x341ef423,0x1a7c6e14,0xb41ef423,0xb49c89ef,0x339f8f93,0xb3b37206,0xb480131a,0xb4cee56d,0x1a7c6e14,0xb43294d2,0xb4af2662,0xb4fe473e,0xb39f8f93,0xb484dc2d,0xb4dc24a8,0xb5150079
.long 0xb41ef423,0xb4af2662,0xb5034280,0xb528b8c8,0xb46ceacc,0xb4d7c0c6,0xb516e33a,0xb53a03f3,0xb49c89ef,0xb4fe473e,0xb528b8c8,0xb548a24f,0xb4c16d7b,0xb5112d68,0xb5388ce3,0xb5545e0c
.long 0x341ef423,0x1a7c6e14,0xb41ef423,0xb49c89ef,0x339f8f93,0xb3b37206,0xb480131a,0xb4cee56d,0x1a7c6e14,0xb43294d2,0xb4af2662,0xb4fe473e,0xb39f8f93,0xb484dc2d,0xb4dc24a8,0xb5150079
.long 0xb41ef423,0xb4af2662,0xb5034280,0xb528b8c8,0xb46ceacc,0xb4d7c0c6,0xb516e33a,0xb53a03f3,0xb49c89ef,0xb4fe473e,0xb528b8c8,0xb548a24f,0xb4c16d7b,0xb5112d68,0xb5388ce3,0xb5545e0c
.long 0xb4e4d82c,0xb513192e,0xb52f4e14,0xb5462f61,0xb50b4fc9,0xb52a65f1,0xb543a44e,0xb5562d46,0xb521d144,0xb53e46f5,0xb5536cb7,0xb560727e,0xb5358df3,0xb54e5610,0xb55e4945,0xb564b8ce
.long 0xb5462f61,0xb55a40b8,0xb563f93e,0xb562e2fa,0xb5536cb7,0xb561c9af,0xb5645abd,0xb55afd8e,0xb55d0bf7,0xb564ca3b,0xb55f6b7e,0xb54d3e8c,0xb562e2fa,0xb56332ee,0xb55548e9,0xb53a03f3
.long 0xb4e4d82c,0xb513192e,0xb52f4e14,0xb5462f61,0xb50b4fc9,0xb52a65f1,0xb543a44e,0xb5562d46,0xb521d144,0xb53e46f5,0xb5536cb7,0xb560727e,0xb5358df3,0xb54e5610,0xb55e4945,0xb564b8ce
.long 0xb5462f61,0xb55a40b8,0xb563f93e,0xb562e2fa,0xb5536cb7,0xb561c9af,0xb5645abd,0xb55afd8e,0xb55d0bf7,0xb564ca3b,0xb55f6b7e,0xb54d3e8c,0xb562e2fa,0xb56332ee,0xb55548e9,0xb53a03f3
.long 0x0,0x341ef423,0x349c89ef,0x34e4d82c,0x0,0x3428c70d,0x34a5e244,0x34f1b0d6,0x0,0x343294d2,0x34af2662,0x34fe473e,0x0,0x343c5d26,0x34b85529,0x35054bf9
.long 0x0,0x34461fbe,0x34c16d7b,0x350b4fc9,0x0,0x344fdc4c,0x34ca6e3c,0x35112d68,0x0,0x34599286,0x34d35652,0x3516e33a,0x0,0x3463421f,0x34dc24a8,0x351c6fb0
.long 0x0,0x341ef423,0x349c89ef,0x34e4d82c,0x0,0x3428c70d,0x34a5e244,0x34f1b0d6,0x0,0x343294d2,0x34af2662,0x34fe473e,0x0,0x343c5d26,0x34b85529,0x35054bf9
.long 0x0,0x34461fbe,0x34c16d7b,0x350b4fc9,0x0,0x344fdc4c,0x34ca6e3c,0x35112d68,0x0,0x34599286,0x34d35652,0x3516e33a,0x0,0x3463421f,0x34dc24a8,0x351c6fb0
.long 0x3513192e,0x352f4e14,0x35462f61,0x35570b1d,0x351a9ae4,0x35371035,0x354d3e8c,0x355c6333,0x3521d144,0x353e46f5,0x35536cb7,0x3560727e,0x3528b8c8,0x3544ecd7,0x3558b31e,0x356332ee
.long 0x352f4e14,0x354afccb,0x355d0bf7,0x3564a069,0x35358df3,0x35507234,0x3560727e,0x3564b8ce,0x353b7558,0x355548e9,0x3562e2fa,0x35637bf7,0x35410164,0x35597d3b,0x35645abd,0x3560ebbf
.long 0x3513192e,0x352f4e14,0x35462f61,0x35570b1d,0x351a9ae4,0x35371035,0x354d3e8c,0x355c6333,0x3521d144,0x353e46f5,0x35536cb7,0x3560727e,0x3528b8c8,0x3544ecd7,0x3558b31e,0x356332ee
.long 0x352f4e14,0x354afccb,0x355d0bf7,0x3564a069,0x35358df3,0x35507234,0x3560727e,0x3564b8ce,0x353b7558,0x355548e9,0x3562e2fa,0x35637bf7,0x35410164,0x35597d3b,0x35645abd,0x3560ebbf
.long 0x35615e25,0x3564d82c,0x35615e25,0x35570b1d,0x3563f93e,0x3563be13,0x355bb3ba,0x354c20c7,0x3564d82c,0x3560727e,0x35536cb7,0x353e46f5,0x3563f93e,0x355afd8e,0x3548a24f,0x352db0a4
.long 0x35615e25,0x35536cb7,0x353b7558,0x351a9ae4,0x355d0bf7,0x3549d2a0,0x352c0de9,0x35054bf9,0x35570b1d,0x353e46f5,0x351a9ae4,0x34dc24a8,0x354f674a,0x3530e62d,0x35075163,0x34aa86ec
.long 0x35615e25,0x3564d82c,0x35615e25,0x35570b1d,0x3563f93e,0x3563be13,0x355bb3ba,0x354c20c7,0x3564d82c,0x3560727e,0x35536cb7,0x353e46f5,0x3563f93e,0x355afd8e,0x3548a24f,0x352db0a4
.long 0x35615e25,0x35536cb7,0x353b7558,0x351a9ae4,0x355d0bf7,0x3549d2a0,0x352c0de9,0x35054bf9,0x35570b1d,0x353e46f5,0x351a9ae4,0x34dc24a8,0x354f674a,0x3530e62d,0x35075163,0x34aa86ec
.long 0x35462f61,0x352f4e14,0x3513192e,0x34e4d82c,0x35358df3,0x3518c163,0x34ed6fcd,0x34a1388e,0x3521d144,0x34fe473e,0x34af2662,0x343294d2,0x350b4fc9,0x34c5f0df,0x34599286,0x32ef9a40
.long 0x34e4d82c,0x3489a133,0x339f8f93,0xb3eef626,0x34af2662,0x34151c63,0xb36f7969,0xb484dc2d,0x346ceacc,0x329fc039,0xb4461fbe,0xb4ca6e3c,0x33eef626,0xb3db25ea,0xb4a5e244,0xb5054bf9
.long 0x35462f61,0x352f4e14,0x3513192e,0x34e4d82c,0x35358df3,0x3518c163,0x34ed6fcd,0x34a1388e,0x3521d144,0x34fe473e,0x34af2662,0x343294d2,0x350b4fc9,0x34c5f0df,0x34599286,0x32ef9a40
.long 0x34e4d82c,0x3489a133,0x339f8f93,0xb3eef626,0x34af2662,0x34151c63,0xb36f7969,0xb484dc2d,0x346ceacc,0x329fc039,0xb4461fbe,0xb4ca6e3c,0x33eef626,0xb3db25ea,0xb4a5e244,0xb5054bf9
.long 0x80003f80,0x80004000,0x80004000,0x80004000,0x80003f80,0xbf053ff7,0xbf803fde,0xbfb53fb5,0x80003f80,0xbf803fde,0xbfde3f80,0xc000250d,0x80003f80,0xbfb53fb5,0xc000250d,0xbfb5bfb5
.long 0x80003f80,0xbfde3f80,0xbfdebf80,0xa58dc000,0x80003f80,0xbff73f05,0xbf80bfde,0x3fb5bfb5,0x80003f80,0xc000250d,0xa58dc000,0x4000a5d4,0x80003f80,0xbff7bf05,0x3f80bfde,0x3fb53fb5
.long 0x80003f80,0xbfdebf80,0x3fdebf80,0x260d4000,0x80003f80,0xbfb5bfb5,0x4000a5d4,0xbfb53fb5,0x80003f80,0xbf80bfde,0x3fde3f80,0xc0002630,0x80003f80,0xbf05bff7,0x3f803fde,0xbfb5bfb5
.long 0x80003f80,0xa58dc000,0x260d4000,0xa654c000,0x80003f80,0x3f05bff7,0xbf803fde,0x3fb5bfb5,0x80003f80,0x3f80bfde,0xbfde3f80,0x4000a677,0x80003f80,0x3fb5bfb5,0xc0002630,0x3fb53fb5
.long 0x80004000,0x80004000,0x80004000,0x80004000,0xbfde3f80,0xbff73f05,0xc000250d,0xbff7bf05,0xbfdebf80,0xbf80bfde,0xa58dc000,0x3f80bfde,0xa58dc000,0x3fb5bfb5,0x4000a5d4,0x3fb53fb5
.long 0x3fdebf80,0x3fde3f80,0x260d4000,0xbfde3f80,0x3fde3f80,0xbf053ff7,0xc0002630,0xbf05bff7,0x260d4000,0xc0002630,0xa654c000,0x4000a677,0xbfde3f80,0xbf05bff7,0x4000a677,0xbf053ff7
.long 0xbfdebf80,0x3fdebf80,0x268d4000,0xbfdebf80,0xa654c000,0x3fb53fb5,0xc000269f,0x3fb5bfb5,0x3fdebf80,0xbf803fde,0xa6b0c000,0x3f803fde,0x3fde3f80,0xbff7bf05,0x4000a7b1,0xbff73f05
.long 0x268d4000,0xa6b0c000,0x26d44000,0xa6f7c000,0xbfde3f80,0x3ff7bf05,0xc000a70d,0x3ff73f05,0xbfdebf80,0x3f803fde,0xa6f7c000,0xbf803fde,0xa6b0c000,0xbfb53fb5,0x4000a7c2,0xbfb5bfb5
.long 0x80004000,0x80004000,0x80004000,0x80004000,0xbfdebf80,0xbfb5bfb5,0xbf80bfde,0xbf05bff7,0x3fdebf80,0x4000a5d4,0x3fde3f80,0x3f803fde,0x260d4000,0xbfb53fb5,0xc0002630,0xbfb5bfb5
.long 0xbfdebf80,0xa654c000,0x3fdebf80,0x3fde3f80,0x3fdebf80,0x3fb53fb5,0xbf803fde,0xbff7bf05,0x268d4000,0xc000269f,0xa6b0c000,0x4000a7b1,0xbfdebf80,0x3fb5bfb5,0x3f803fde,0xbff73f05
.long 0x3fdebf80,0x26d44000,0xbfdebf80,0x3fdebf80,0x26d44000,0xbfb5bfb5,0x4000a7c2,0xbfb53fb5,0xbfdebf80,0x4000a7c2,0xbfde3f80,0x3f80bfde,0x3fdebf80,0xbfb53fb5,0x3f80bfde,0xbf053ff7
.long 0x270d4000,0xa71fc000,0x27304000,0xa831c000,0xbfdebf80,0x3fb53fb5,0xbf80bfde,0x3f053ff7,0x3fdebf80,0xc000a68d,0x3fde3f80,0xbf80bfde,0x27304000,0x3fb5bfb5,0xc000a60e,0x3fb53fb5
.long 0x80003f80,0x80000000,0x80000000,0x80000000,0xa50dbf80,0x8000,0x8000,0x8000,0x258d3f80,0x80000000,0x80000000,0x80000000,0xa5d4bf80,0x8000,0x8000,0x0
.long 0x260d3f80,0x80000000,0x80008000,0x80008000,0xa630bf80,0x8000,0x0,0x80000000,0x26543f80,0x80008000,0x80008000,0x8000,0xa677bf80,0x0,0x80000000,0x80008000
.long 0x268d3f80,0x80008000,0x8000,0x0,0xa69fbf80,0x0,0x80008000,0x8000,0x26b03f80,0x80008000,0x0,0x80008000,0xa7b1bf80,0x0,0x80008000,0x0
.long 0x26d43f80,0x8000,0x0,0x80008000,0x270dbf80,0x80000000,0x8000,0x80000000,0x26f73f80,0x8000,0x80000000,0x8000,0xa7c2bf80,0x80000000,0x8000,0x80008000
.long 0x80003f80,0x3fdebf80,0xbfdebf80,0x268d4000,0x80003f80,0x3ff7bf05,0xbf80bfde,0xbfb53fb5,0x80003f80,0x4000a5d4,0xa654c000,0xc000269f,0x80003f80,0x3ff73f05,0x3f80bfde,0xbfb5bfb5
.long 0x80003f80,0x3fde3f80,0x3fdebf80,0xa6b0c000,0x80003f80,0x3fb53fb5,0x4000a677,0x3fb5bfb5,0x80003f80,0x3f803fde,0x3fde3f80,0x4000a7b1,0x80003f80,0x3f053ff7,0x3f803fde,0x3fb53fb5
.long 0x80000000,0x8000,0x80008000,0x0,0x80000000,0x8000,0x80008000,0x80000000,0x80000000,0x8000,0x80008000,0x80000000,0x80000000,0x0,0x8000,0x80008000
.long 0x80000000,0x0,0x8000,0x80008000,0x80000000,0x0,0x8000,0x8000,0x80000000,0x0,0x0,0x8000,0x80000000,0x0,0x0,0x0
.long 0x3fdebf80,0xbfdebf80,0x270d4000,0x3fdebf80,0x3fde3f80,0x3f05bff7,0xc000a6d4,0x3f053ff7,0x26d44000,0x4000a7c2,0xa71fc000,0xc000a68d,0xbfde3f80,0x3f053ff7,0x4000a7d4,0x3f05bff7
.long 0xbfdebf80,0xbfde3f80,0x27304000,0x3fde3f80,0xa6f7c000,0xbfb5bfb5,0xc000a68d,0xbfb53fb5,0x3fdebf80,0x3f80bfde,0xa831c000,0xbf80bfde,0x3fde3f80,0x3ff73f05,0x4000a7e5,0x3ff7bf05
.long 0x8000,0x80008000,0x0,0x8000,0x0,0x8000,0x80008000,0x0,0x0,0x8000,0x80008000,0x80008000,0x80000000,0x0,0x8000,0x8000
.long 0x80008000,0x80000000,0x0,0x0,0x80008000,0x80008000,0x80008000,0x80000000,0x8000,0x8000,0x80008000,0x80008000,0x0,0x0,0x8000,0x8000
.long 0xbfdebf80,0x27544000,0x3fdebf80,0xbfdebf80,0x3fdebf80,0xbfb5bfb5,0xbf803fde,0x3ff73f05,0x27544000,0x4000a7f7,0xa842c000,0xc000260d,0xbfdebf80,0xbfb53fb5,0x3f803fde,0x3ff7bf05
.long 0x3fdebf80,0xa842c000,0xbfdebf80,0xbfde3f80,0x27774000,0x3fb53fb5,0x4000a80d,0x3fb5bfb5,0xbfdebf80,0xc000260d,0xbfde3f80,0xbf803fde,0x3fdebf80,0x3fb5bfb5,0x3f80bfde,0x3f05bff7
.long 0x80008000,0x0,0x8000,0x80008000,0x8000,0x80008000,0x80000000,0x0,0x0,0x8000,0x80008000,0x80000000,0x80008000,0x80000000,0x0,0x8000
.long 0x8000,0x80008000,0x80008000,0x80000000,0x0,0x0,0x8000,0x8000,0x80008000,0x80000000,0x80000000,0x80000000,0x8000,0x8000,0x8000,0x8000
.long 0x270d3f80,0x8000,0x80008000,0x0,0x26d4bf80,0x80000000,0x0,0x8000,0x271f3f80,0x8000,0x8000,0x80000000,0xa7d4bf80,0x80008000,0x80000000,0x0
.long 0x27303f80,0x0,0x8000,0x8000,0x268dbf80,0x80008000,0x80000000,0x80000000,0x28313f80,0x0,0x0,0x0,0xa7e5bf80,0x80008000,0x80008000,0x80008000
.long 0x0,0x8000,0x80008000,0x0,0x8000,0x80000000,0x0,0x8000,0x0,0x8000,0x8000,0x80000000,0x80008000,0x80008000,0x80000000,0x0
.long 0x0,0x0,0x8000,0x8000,0x8000,0x80008000,0x80000000,0x80000000,0x0,0x0,0x0,0x0,0x80008000,0x80008000,0x80008000,0x80008000
.long 0x80000000,0x8000,0x80008000,0x0,0x80000000,0x8000,0x80008000,0x80000000,0x80000000,0x8000,0x80008000,0x80000000,0x80000000,0x0,0x8000,0x80008000
.long 0x80000000,0x0,0x8000,0x80008000,0x80000000,0x0,0x8000,0x8000,0x80000000,0x0,0x0,0x8000,0x80000000,0x0,0x0,0x0
.long 0x80003f80,0x3fdebf80,0xbfdebf80,0x268d4000,0x80003f80,0x3ff7bf05,0xbf80bfde,0xbfb53fb5,0x80003f80,0x4000a5d4,0xa654c000,0xc000269f,0x80003f80,0x3ff73f05,0x3f80bfde,0xbfb5bfb5
.long 0x80003f80,0x3fde3f80,0x3fdebf80,0xa6b0c000,0x80003f80,0x3fb53fb5,0x4000a677,0x3fb5bfb5,0x80003f80,0x3f803fde,0x3fde3f80,0x4000a7b1,0x80003f80,0x3f053ff7,0x3f803fde,0x3fb53fb5
.long 0x8000,0x80008000,0x0,0x8000,0x0,0x8000,0x80008000,0x0,0x0,0x8000,0x80008000,0x80008000,0x80000000,0x0,0x8000,0x8000
.long 0x80008000,0x80000000,0x0,0x0,0x80008000,0x80008000,0x80008000,0x80000000,0x8000,0x8000,0x80008000,0x80008000,0x0,0x0,0x8000,0x8000
.long 0x3fdebf80,0xbfdebf80,0x270d4000,0x3fdebf80,0x3fde3f80,0x3f05bff7,0xc000a6d4,0x3f053ff7,0x26d44000,0x4000a7c2,0xa71fc000,0xc000a68d,0xbfde3f80,0x3f053ff7,0x4000a7d4,0x3f05bff7
.long 0xbfdebf80,0xbfde3f80,0x27304000,0x3fde3f80,0xa6f7c000,0xbfb5bfb5,0xc000a68d,0xbfb53fb5,0x3fdebf80,0x3f80bfde,0xa831c000,0xbf80bfde,0x3fde3f80,0x3ff73f05,0x4000a7e5,0x3ff7bf05
.long 0x80008000,0x0,0x8000,0x80008000,0x8000,0x80008000,0x80000000,0x0,0x0,0x8000,0x80008000,0x80000000,0x80008000,0x80000000,0x0,0x8000
.long 0x8000,0x80008000,0x80008000,0x80000000,0x0,0x0,0x8000,0x8000,0x80008000,0x80000000,0x80000000,0x80000000,0x8000,0x8000,0x8000,0x8000
.long 0xbfdebf80,0x27544000,0x3fdebf80,0xbfdebf80,0x3fdebf80,0xbfb5bfb5,0xbf803fde,0x3ff73f05,0x27544000,0x4000a7f7,0xa842c000,0xc000260d,0xbfdebf80,0xbfb53fb5,0x3f803fde,0x3ff7bf05
.long 0x3fdebf80,0xa842c000,0xbfdebf80,0xbfde3f80,0x27774000,0x3fb53fb5,0x4000a80d,0x3fb5bfb5,0xbfdebf80,0xc000260d,0xbfde3f80,0xbf803fde,0x3fdebf80,0x3fb5bfb5,0x3f80bfde,0x3f05bff7
.long 0x0,0x8000,0x80008000,0x0,0x8000,0x80000000,0x0,0x8000,0x0,0x8000,0x8000,0x80000000,0x80008000,0x80008000,0x80000000,0x0
.long 0x0,0x0,0x8000,0x8000,0x8000,0x80008000,0x80000000,0x80000000,0x0,0x0,0x0,0x0,0x80008000,0x80008000,0x80008000,0x80008000
.long 0x270d3f80,0x8000,0x80008000,0x0,0x26d4bf80,0x80000000,0x0,0x8000,0x271f3f80,0x8000,0x8000,0x80000000,0xa7d4bf80,0x80008000,0x80000000,0x0
.long 0x27303f80,0x0,0x8000,0x8000,0x268dbf80,0x80008000,0x80000000,0x80000000,0x28313f80,0x0,0x0,0x0,0xa7e5bf80,0x80008000,0x80008000,0x80008000
.long 0x0,0x620,0xc00,0x1220,0x40,0x660,0xc40,0x1260,0x80,0x6a0,0xc80,0x12a0,0xc0,0x6e0,0xcc0,0x12e0
.long 0x110,0x730,0xd10,0x1330,0x150,0x770,0xd50,0x1370,0x190,0x7b0,0xd90,0x13b0,0x1d0,0x7f0,0xdd0,0x13f0
.long 0x220,0x800,0xe20,0x1400,0x260,0x840,0xe60,0x1440,0x2a0,0x880,0xea0,0x1480,0x2e0,0x8c0,0xee0,0x14c0
.long 0x330,0x910,0xf30,0x1510,0x330,0x910,0xf30,0x1510,0x330,0x910,0xf30,0x1510,0x330,0x910,0xf30,0x1510
.long 0x2400,0x2a20,0x3000,0x3620,0x2440,0x2a60,0x3040,0x3660,0x2480,0x2aa0,0x3080,0x36a0,0x24c0,0x2ae0,0x30c0,0x36e0
.long 0x2510,0x2b30,0x3110,0x3730,0x2550,0x2b70,0x3150,0x3770,0x2590,0x2bb0,0x3190,0x37b0,0x25d0,0x2bf0,0x31d0,0x37f0
.long 0x2620,0x2c00,0x3220,0x3800,0x2660,0x2c40,0x3260,0x3840,0x26a0,0x2c80,0x32a0,0x3880,0x26e0,0x2cc0,0x32e0,0x38c0
.long 0x2730,0x2d10,0x3330,0x3910,0x2730,0x2d10,0x3330,0x3910,0x2730,0x2d10,0x3330,0x3910,0x2730,0x2d10,0x3330,0x3910
.long 0x4800,0x4220,0x3c00,0x3620,0x47f0,0x41d0,0x3bf0,0x35d0,0x47b0,0x4190,0x3bb0,0x3590,0x4770,0x4150,0x3b70,0x3550
.long 0x4730,0x4110,0x3b30,0x3510,0x46e0,0x40c0,0x3ae0,0x34c0,0x46a0,0x4080,0x3aa0,0x3480,0x4660,0x4040,0x3a60,0x3440
.long 0x4620,0x4000,0x3a20,0x3400,0x45d0,0x3ff0,0x39d0,0x33f0,0x4590,0x3fb0,0x3990,0x33b0,0x4550,0x3f70,0x3950,0x3370
.long 0x4510,0x3f30,0x3910,0x3330,0x4510,0x3f30,0x3910,0x3330,0x4510,0x3f30,0x3910,0x3330,0x4510,0x3f30,0x3910,0x3330
.long 0x2400,0x1e20,0x1800,0x1220,0x23f0,0x1dd0,0x17f0,0x11d0,0x23b0,0x1d90,0x17b0,0x1190,0x2370,0x1d50,0x1770,0x1150
.long 0x2330,0x1d10,0x1730,0x1110,0x22e0,0x1cc0,0x16e0,0x10c0,0x22a0,0x1c80,0x16a0,0x1080,0x2260,0x1c40,0x1660,0x1040
.long 0x2220,0x1c00,0x1620,0x1000,0x21d0,0x1bf0,0x15d0,0xff0,0x2190,0x1bb0,0x1590,0xfb0,0x2150,0x1b70,0x1550,0xf70
.long 0x2110,0x1b30,0x1510,0xf30,0x2110,0x1b30,0x1510,0xf30,0x2110,0x1b30,0x1510,0xf30,0x2110,0x1b30,0x1510,0xf30
.long 0x1800,0x1e20,0x0,0x20,0x1840,0x1e60,0x30,0x50,0x1880,0x1ea0,0x60,0x80,0x18c0,0x1ee0,0x90,0xb0
.long 0x1910,0x1f30,0xc0,0xe0,0x1950,0x1f70,0xf0,0x110,0x1990,0x1fb0,0x120,0x140,0x19d0,0x1ff0,0x150,0x170
.long 0x1a20,0x2000,0x180,0x1a0,0x1a60,0x2040,0x1b0,0x1d0,0x1aa0,0x2080,0x1e0,0x200,0x1ae0,0x20c0,0x210,0x230
.long 0x1b30,0x2110,0x240,0x260,0x1b30,0x2110,0x270,0x290,0x1b30,0x2110,0x2a0,0x2c0,0x1b30,0x2110,0x2d0,0x2f0
.long 0x3c00,0x4220,0x8,0x28,0x3c40,0x4260,0x38,0x58,0x3c80,0x42a0,0x68,0x88,0x3cc0,0x42e0,0x98,0xb8
.long 0x3d10,0x4330,0xc8,0xe8,0x3d50,0x4370,0xf8,0x118,0x3d90,0x43b0,0x128,0x148,0x3dd0,0x43f0,0x158,0x178
.long 0x3e20,0x4400,0x188,0x1a8,0x3e60,0x4440,0x1b8,0x1d8,0x3ea0,0x4480,0x1e8,0x208,0x3ee0,0x44c0,0x218,0x238
.long 0x3f30,0x4510,0x248,0x268,0x3f30,0x4510,0x278,0x298,0x3f30,0x4510,0x2a8,0x2c8,0x3f30,0x4510,0x2d8,0x2f8
.long 0x3000,0x2a20,0x10,0x4a0,0x2ff0,0x29d0,0x40,0x4d0,0x2fb0,0x2990,0x70,0x500,0x2f70,0x2950,0xa0,0x530
.long 0x2f30,0x2910,0xd0,0x560,0x2ee0,0x28c0,0x100,0x590,0x2ea0,0x2880,0x130,0x5c0,0x2e60,0x2840,0x160,0x5f0
.long 0x2e20,0x2800,0x190,0x620,0x2dd0,0x27f0,0x1c0,0x650,0x2d90,0x27b0,0x1f0,0x680,0x2d50,0x2770,0x220,0x6b0
.long 0x2d10,0x2730,0x250,0x6e0,0x2d10,0x2730,0x280,0x710,0x2d10,0x2730,0x2b0,0x740,0x2d10,0x2730,0x2e0,0x770
.long 0xc00,0x620,0x18,0x4a8,0xbf0,0x5d0,0x48,0x4d8,0xbb0,0x590,0x78,0x508,0xb70,0x550,0xa8,0x538
.long 0xb30,0x510,0xd8,0x568,0xae0,0x4c0,0x108,0x598,0xaa0,0x480,0x138,0x5c8,0xa60,0x440,0x168,0x5f8
.long 0xa20,0x400,0x198,0x628,0x9d0,0x3f0,0x1c8,0x658,0x990,0x3b0,0x1f8,0x688,0x950,0x370,0x228,0x6b8
.long 0x910,0x330,0x258,0x6e8,0x910,0x330,0x288,0x718,0x910,0x330,0x2b8,0x748,0x910,0x330,0x2e8,0x778
.long 0x300,0x320,0x0,0x0,0x330,0x350,0x0,0x0,0x360,0x380,0x0,0x0,0x390,0x3b0,0x0,0x0
.long 0x3c0,0x3e0,0x0,0x0,0x3f0,0x410,0x0,0x0,0x420,0x440,0x0,0x0,0x450,0x470,0x0,0x0
.long 0x780,0x320,0x0,0x0,0x7b0,0x350,0x0,0x0,0x7e0,0x380,0x0,0x0,0x810,0x3b0,0x0,0x0
.long 0x840,0x3e0,0x0,0x0,0x870,0x410,0x0,0x0,0x8a0,0x440,0x0,0x0,0x8d0,0x470,0x0,0x0
.long 0x308,0x328,0x0,0x0,0x338,0x358,0x0,0x0,0x368,0x388,0x0,0x0,0x398,0x3b8,0x0,0x0
.long 0x3c8,0x3e8,0x0,0x0,0x3f8,0x418,0x0,0x0,0x428,0x448,0x0,0x0,0x458,0x478,0x0,0x0
.long 0x788,0x328,0x0,0x0,0x7b8,0x358,0x0,0x0,0x7e8,0x388,0x0,0x0,0x818,0x3b8,0x0,0x0
.long 0x848,0x3e8,0x0,0x0,0x878,0x418,0x0,0x0,0x8a8,0x448,0x0,0x0,0x8d8,0x478,0x0,0x0
.long 0x310,0x7a0,0x0,0x0,0x340,0x7d0,0x0,0x0,0x370,0x800,0x0,0x0,0x3a0,0x830,0x0,0x0
.long 0x3d0,0x860,0x0,0x0,0x400,0x890,0x0,0x0,0x430,0x8c0,0x0,0x0,0x460,0x8f0,0x0,0x0
.long 0x790,0x7a0,0x0,0x0,0x7c0,0x7d0,0x0,0x0,0x7f0,0x800,0x0,0x0,0x820,0x830,0x0,0x0
.long 0x850,0x860,0x0,0x0,0x880,0x890,0x0,0x0,0x8b0,0x8c0,0x0,0x0,0x8e0,0x8f0,0x0,0x0
.long 0x318,0x7a8,0x0,0x0,0x348,0x7d8,0x0,0x0,0x378,0x808,0x0,0x0,0x3a8,0x838,0x0,0x0
.long 0x3d8,0x868,0x0,0x0,0x408,0x898,0x0,0x0,0x438,0x8c8,0x0,0x0,0x468,0x8f8,0x0,0x0
.long 0x798,0x7a8,0x0,0x0,0x7c8,0x7d8,0x0,0x0,0x7f8,0x808,0x0,0x0,0x828,0x838,0x0,0x0
.long 0x858,0x868,0x0,0x0,0x888,0x898,0x0,0x0,0x8b8,0x8c8,0x0,0x0,0x8e8,0x8f8,0x0,0x0
.section .rodata,"a"
.p2align 6
.amdhsa_kernel concat_heads__ssm_conv_s4__spectral_gfnet__prompt_kernel
  .amdhsa_next_free_vgpr 128
  .amdhsa_next_free_sgpr 102
  .amdhsa_accum_offset 128
  .amdhsa_group_segment_fixed_size 0
  .amdhsa_kernarg_size 120
  .amdhsa_user_sgpr_count 2
  .amdhsa_user_sgpr_kernarg_segment_ptr 1
  .amdhsa_system_sgpr_workgroup_id_x 1
.end_amdhsa_kernel
```
